```python
import torch

def _softmax(x, axis=-1):
    return torch.softmax(x, dim=axis)
def _gelu(x):
    return torch.nn.functional.gelu(x, approximate="tanh")
def _silu(x):
    return torch.nn.functional.silu(x)
def _sigmoid(x):
    return torch.sigmoid(x)
def _layernorm(x, axis=-1, eps=1e-5):
    m = x.mean(dim=axis, keepdim=True)
    v = x.var(dim=axis, keepdim=True, unbiased=False)
    return (x - m) / torch.sqrt(v + eps)
def _scatter_add(tgt, idx, src, axis=0):
    return tgt.clone().index_add_(axis, idx, src)
def _segment_sum(src, seg, n):
    out = torch.zeros((n,) + src.shape[1:], dtype=src.dtype)
    return out.index_add_(0, seg, src)
def _pad(x, pw):
    flat = tuple(v for pair in reversed(pw) for v in pair)
    return torch.nn.functional.pad(x, flat)

kernel_name = 'gather_scatter__molecular_angular_gemnet__graph'

def setup_inputs():

    _w = (lambda a: (lambda t: t.to(torch.bfloat16) if t.is_floating_point() else t)(torch.as_tensor(a)))
    N, deg, De, L = 50000, 16, 16, 1
    E = N * deg
    T = E * deg
    NR = 8
    dist = torch.rand(E).to(float)
    angle = (torch.rand(T) * torch.pi).to(float)
    centers = torch.linspace(0.0, 1.0, NR).to(float)
    ang_freq = torch.arange(1, L + 1).to(float)
    return {
        "m": _w((lambda *s: torch.randn(*s, dtype=torch.bfloat16) * 0.05)(E, De)),
        "idx_in": _w((lambda lo, hi, *s: torch.randint(lo, hi, s))(0, E, T).to(torch.int64)),
        "idx_out": _w((lambda lo, hi, *s: torch.randint(lo, hi, s))(0, E, T).to(torch.int64)),
        "dist": _w(dist),
        "angle": _w(angle),
        "centers": _w(centers),
        "ang_freq": _w(ang_freq),
        "w_rbf": _w((lambda *s: torch.randn(*s, dtype=torch.bfloat16) * 0.2)(NR, De)),
        "w_sbf": _w((lambda *s: torch.randn(*s, dtype=torch.bfloat16) * 0.2)(NR * L, De)),
        "w_down": _w((lambda *s: torch.randn(*s, dtype=torch.bfloat16) * 0.2)(De, De)),
        "w_up": _w((lambda *s: torch.randn(*s, dtype=torch.bfloat16) * 0.2)(De, De)),
    }

def reference(m, idx_in, idx_out, dist, angle, centers, ang_freq, w_rbf, w_sbf, w_down, w_up):
    E, De = m.shape[0], m.shape[1]
    NR = centers.shape[0]
    L = ang_freq.shape[0]
    rbf = torch.exp(-10.0 * (dist[:, None] - centers[None, :]) ** 2)
    cbf = torch.cos(ang_freq[None, :] * angle[:, None])
    rbf_t = rbf[idx_out]
    sbf = torch.reshape(rbf_t[:, :, None] * cbf[:, None, :], (-1, NR * L))
    x = (m[idx_in] @ w_down) * (sbf @ w_sbf)
    agg = _segment_sum(x, idx_out, E)
    return m + (agg @ w_up) * (rbf @ w_rbf)
```

```asm
; @launch kernel=gs_part_kernel grid=(256,1,1) block=(1024,1,1) lds=163840
; @launch kernel=gather_scatter__molecular_angular_gemnet__graph_kernel grid=(256,1,1) block=(896,1,1) lds=133648
.amdgcn_target "amdgcn-amd-amdhsa--gfx950"
.text
.globl gs_part_kernel
.p2align 8
.type gs_part_kernel,@function
gs_part_kernel:
    s_cmp_ge_u32 s2, 256
    s_cbranch_scc1 L_k1_end
    s_load_dwordx2 s[4:5], s[0:1], 8
    s_load_dwordx2 s[8:9], s[0:1], 16
    s_load_dwordx2 s[12:13], s[0:1], 32
    s_load_dwordx2 s[24:25], s[0:1], 104
    s_load_dwordx2 s[26:27], s[0:1], 48
    s_load_dwordx2 s[96:97], s[0:1], 0
    s_mov_b32 s98, 25600000
    s_mov_b32 s99, 0x20000
    s_mov_b32 s6, 51200000
    s_mov_b32 s7, 0x20000
    s_mov_b32 s10, 51200000
    s_mov_b32 s11, 0x20000
    s_mov_b32 s14, 25600004
    s_mov_b32 s15, 0x20000
    s_mov_b32 s19, 0x20000
    s_mov_b32 s22, 3072
    s_mov_b32 s23, 0x20000
    s_mov_b32 s28, 1373072
    s_mov_b32 s29, 28709
    s_mov_b32 s30, -3128
    s_mov_b32 s31, 0xffff0000
    s_mov_b32 s40, 0x2aaaaaab
    s_movk_i32 s41, 0xe0
    s_movk_i32 s50, 0
    s_mov_b32 s51, 4675
    s_mov_b32 s93, 0
    s_movk_i32 s3, 0
    s_lshl_b32 s42, s2, 14
    s_lshr_b32 s43, s2, 1
    s_mul_i32 s43, s43, 3392
    s_and_b32 s39, s2, 1
    s_mul_i32 s39, s39, 1696
    s_add_u32 s43, s43, s39
    s_getpc_b64 s[94:95]
    v_min_u32 v27, 243, v0
    v_lshlrev_b32 v27, 7, v27
    s_cmp_ge_u32 s2, 8
    s_cbranch_scc1 L_k1_nocp
    global_load_dword v27, v27, s[94:95]
L_k1_nocp:
    v_lshlrev_b32 v1, 4, v0
    v_lshlrev_b32 v2, 3, v0
    v_mov_b32 v3, 6
    v_lshrrev_b32 v4, 6, v0
    v_mov_b32 v8, 0
    v_mov_b32 v9, 0
    v_mov_b32 v10, 0
    v_mov_b32 v11, 0
    v_readfirstlane_b32 s38, v4
    s_getreg_b32 vcc_lo, hwreg(HW_REG_XCC_ID, 0, 1)
    s_mov_b32 vcc_hi, 0
    s_movk_i32 s39, 424
    s_bitcmp1_b32 s2, 0
    s_cselect_b32 s39, 424, s39
    v_cmp_gt_u32 s[36:37], s39, v0
    s_waitcnt lgkmcnt(0)
    s_load_dword s44, s[26:27], 0
    s_setprio 3
    s_add_u32 s34, s42, 0
    s_lshr_b32 s35, s34, 1
    buffer_load_dwordx4 v[52:55], v1, s[8:11], s34 offen nt
    buffer_load_dwordx4 v[28:31], v1, s[4:7], s34 offen nt
    buffer_load_dwordx2 v[14:15], v2, s[12:15], s35 offen nt
    ds_write_b128 v1, v[8:11]
    s_waitcnt lgkmcnt(0)
    s_lshl_b32 s32, s44, 16
    s_lshl_b32 s33, s44, 16
    s_mov_b32 s100, 0x3e22f900
    s_mov_b32 s101, 0x36036e4e
    s_barrier
    s_waitcnt vmcnt(0)
    s_add_u32 s34, s42, 4194304
    s_lshr_b32 s35, s34, 1
    buffer_load_dwordx4 v[56:59], v1, s[8:11], s34 offen nt
    buffer_load_dwordx4 v[32:35], v1, s[4:7], s34 offen nt
    buffer_load_dwordx2 v[16:17], v2, s[12:15], s35 offen nt
    s_waitcnt vmcnt(3)
    v_lshlrev_b32 v8, 16, v14
    v_and_b32 v9, s31, v14
    v_lshlrev_b32 v10, 16, v15
    v_and_b32 v11, s31, v15
    v_pk_mul_f32 v[8:9], v[8:9], s[32:33]
    v_pk_mul_f32 v[10:11], v[10:11], s[32:33]
    v_cvt_pk_bf16_f32 v8, 0, v8
    v_cvt_pk_bf16_f32 v9, 0, v9
    v_cvt_pk_bf16_f32 v10, 0, v10
    v_cvt_pk_bf16_f32 v11, 0, v11
    v_mul_f32 v4, s100, v8
    v_mul_f32 v5, s100, v9
    v_mul_f32 v6, s100, v10
    v_mul_f32 v7, s100, v11
    v_fract_f32 v4, v4
    v_fract_f32 v5, v5
    v_fract_f32 v6, v6
    v_fract_f32 v7, v7
    v_fma_f32 v8, v8, s101, v4
    v_fma_f32 v9, v9, s101, v5
    v_fma_f32 v10, v10, s101, v6
    v_fma_f32 v11, v11, s101, v7
    v_fract_f32 v8, v8
    v_fract_f32 v9, v9
    v_fract_f32 v10, v10
    v_fract_f32 v11, v11
    v_cos_f32 v8, v8
    v_mul_hi_u32_u24 v4, s28, v52
    v_mad_i32_i24 v52, v4, s30, v52
    v_and_b32 v5, 16, v4
    v_mad_u32_u24 v5, v5, s51, v28
    v_lshl_or_b32 v28, v52, 20, v28
    v_mul_hi_u32_u24 v5, s29, v5
    v_lshlrev_b32 v4, 2, v4
    v_lshl_or_b32 v52, v5, 10, v4
    ds_add_u32 v52, v3
    v_cos_f32 v9, v9
    v_mul_hi_u32_u24 v6, s28, v53
    v_mad_i32_i24 v53, v6, s30, v53
    v_and_b32 v7, 16, v6
    v_mad_u32_u24 v7, v7, s51, v29
    v_lshl_or_b32 v29, v53, 20, v29
    v_mul_hi_u32_u24 v7, s29, v7
    v_lshlrev_b32 v6, 2, v6
    v_lshl_or_b32 v53, v7, 10, v6
    ds_add_u32 v53, v3
    v_cos_f32 v10, v10
    v_mul_hi_u32_u24 v4, s28, v54
    v_mad_i32_i24 v54, v4, s30, v54
    v_and_b32 v5, 16, v4
    v_mad_u32_u24 v5, v5, s51, v30
    v_lshl_or_b32 v30, v54, 20, v30
    v_mul_hi_u32_u24 v5, s29, v5
    v_lshlrev_b32 v4, 2, v4
    v_lshl_or_b32 v54, v5, 10, v4
    ds_add_u32 v54, v3
    v_cos_f32 v11, v11
    v_mul_hi_u32_u24 v6, s28, v55
    v_mad_i32_i24 v55, v6, s30, v55
    v_and_b32 v7, 16, v6
    v_mad_u32_u24 v7, v7, s51, v31
    v_lshl_or_b32 v31, v55, 20, v31
    v_mul_hi_u32_u24 v7, s29, v7
    v_lshlrev_b32 v6, 2, v6
    v_lshl_or_b32 v55, v7, 10, v6
    ds_add_u32 v55, v3
    v_cvt_pk_bf16_f32 v8, v8, v9
    v_cvt_pk_bf16_f32 v10, v10, v11
    v_lshl_or_b32 v52, v8, 16, v52
    v_and_or_b32 v53, v8, s31, v53
    v_lshl_or_b32 v54, v10, 16, v54
    v_and_or_b32 v55, v10, s31, v55
    s_waitcnt vmcnt(0)
    s_setprio 2
    s_add_u32 s34, s42, 8388608
    s_lshr_b32 s35, s34, 1
    buffer_load_dwordx4 v[60:63], v1, s[8:11], s34 offen nt
    buffer_load_dwordx4 v[36:39], v1, s[4:7], s34 offen nt
    buffer_load_dwordx2 v[18:19], v2, s[12:15], s35 offen nt
    s_waitcnt vmcnt(3)
    v_lshlrev_b32 v8, 16, v16
    v_and_b32 v9, s31, v16
    v_lshlrev_b32 v10, 16, v17
    v_and_b32 v11, s31, v17
    v_pk_mul_f32 v[8:9], v[8:9], s[32:33]
    v_pk_mul_f32 v[10:11], v[10:11], s[32:33]
    v_cvt_pk_bf16_f32 v8, 0, v8
    v_cvt_pk_bf16_f32 v9, 0, v9
    v_cvt_pk_bf16_f32 v10, 0, v10
    v_cvt_pk_bf16_f32 v11, 0, v11
    v_mul_f32 v4, s100, v8
    v_mul_f32 v5, s100, v9
    v_mul_f32 v6, s100, v10
    v_mul_f32 v7, s100, v11
    v_fract_f32 v4, v4
    v_fract_f32 v5, v5
    v_fract_f32 v6, v6
    v_fract_f32 v7, v7
    v_fma_f32 v8, v8, s101, v4
    v_fma_f32 v9, v9, s101, v5
    v_fma_f32 v10, v10, s101, v6
    v_fma_f32 v11, v11, s101, v7
    v_fract_f32 v8, v8
    v_fract_f32 v9, v9
    v_fract_f32 v10, v10
    v_fract_f32 v11, v11
    v_cos_f32 v8, v8
    v_mul_hi_u32_u24 v4, s28, v56
    v_mad_i32_i24 v56, v4, s30, v56
    v_and_b32 v5, 16, v4
    v_mad_u32_u24 v5, v5, s51, v32
    v_lshl_or_b32 v32, v56, 20, v32
    v_mul_hi_u32_u24 v5, s29, v5
    v_lshlrev_b32 v4, 2, v4
    v_lshl_or_b32 v56, v5, 10, v4
    ds_add_u32 v56, v3
    v_cos_f32 v9, v9
    v_mul_hi_u32_u24 v6, s28, v57
    v_mad_i32_i24 v57, v6, s30, v57
    v_and_b32 v7, 16, v6
    v_mad_u32_u24 v7, v7, s51, v33
    v_lshl_or_b32 v33, v57, 20, v33
    v_mul_hi_u32_u24 v7, s29, v7
    v_lshlrev_b32 v6, 2, v6
    v_lshl_or_b32 v57, v7, 10, v6
    ds_add_u32 v57, v3
    v_cos_f32 v10, v10
    v_mul_hi_u32_u24 v4, s28, v58
    v_mad_i32_i24 v58, v4, s30, v58
    v_and_b32 v5, 16, v4
    v_mad_u32_u24 v5, v5, s51, v34
    v_lshl_or_b32 v34, v58, 20, v34
    v_mul_hi_u32_u24 v5, s29, v5
    v_lshlrev_b32 v4, 2, v4
    v_lshl_or_b32 v58, v5, 10, v4
    ds_add_u32 v58, v3
    v_cos_f32 v11, v11
    v_mul_hi_u32_u24 v6, s28, v59
    v_mad_i32_i24 v59, v6, s30, v59
    v_and_b32 v7, 16, v6
    v_mad_u32_u24 v7, v7, s51, v35
    v_lshl_or_b32 v35, v59, 20, v35
    v_mul_hi_u32_u24 v7, s29, v7
    v_lshlrev_b32 v6, 2, v6
    v_lshl_or_b32 v59, v7, 10, v6
    ds_add_u32 v59, v3
    v_cvt_pk_bf16_f32 v8, v8, v9
    v_cvt_pk_bf16_f32 v10, v10, v11
    v_lshl_or_b32 v56, v8, 16, v56
    v_and_or_b32 v57, v8, s31, v57
    v_lshl_or_b32 v58, v10, 16, v58
    v_and_or_b32 v59, v10, s31, v59
    s_waitcnt vmcnt(0)
    s_add_u32 s34, s42, 12582912
    s_lshr_b32 s35, s34, 1
    s_cbranch_vccnz L_th_1
    s_waitcnt vmcnt(1)
L_th_1:
    buffer_load_dwordx4 v[64:67], v1, s[8:11], s34 offen nt
    s_cbranch_vccnz L_th_2
    s_waitcnt vmcnt(1)
L_th_2:
    buffer_load_dwordx4 v[40:43], v1, s[4:7], s34 offen nt
    s_cbranch_vccnz L_th_3
    s_waitcnt vmcnt(1)
L_th_3:
    buffer_load_dwordx2 v[20:21], v2, s[12:15], s35 offen nt
    s_waitcnt vmcnt(3)
    v_lshlrev_b32 v8, 16, v18
    v_and_b32 v9, s31, v18
    v_lshlrev_b32 v10, 16, v19
    v_and_b32 v11, s31, v19
    v_pk_mul_f32 v[8:9], v[8:9], s[32:33]
    v_pk_mul_f32 v[10:11], v[10:11], s[32:33]
    v_cvt_pk_bf16_f32 v8, 0, v8
    v_cvt_pk_bf16_f32 v9, 0, v9
    v_cvt_pk_bf16_f32 v10, 0, v10
    v_cvt_pk_bf16_f32 v11, 0, v11
    v_mul_f32 v4, s100, v8
    v_mul_f32 v5, s100, v9
    v_mul_f32 v6, s100, v10
    v_mul_f32 v7, s100, v11
    v_fract_f32 v4, v4
    v_fract_f32 v5, v5
    v_fract_f32 v6, v6
    v_fract_f32 v7, v7
    v_fma_f32 v8, v8, s101, v4
    v_fma_f32 v9, v9, s101, v5
    v_fma_f32 v10, v10, s101, v6
    v_fma_f32 v11, v11, s101, v7
    v_fract_f32 v8, v8
    v_fract_f32 v9, v9
    v_fract_f32 v10, v10
    v_fract_f32 v11, v11
    v_cos_f32 v8, v8
    v_mul_hi_u32_u24 v4, s28, v60
    v_mad_i32_i24 v60, v4, s30, v60
    v_and_b32 v5, 16, v4
    v_mad_u32_u24 v5, v5, s51, v36
    v_lshl_or_b32 v36, v60, 20, v36
    v_mul_hi_u32_u24 v5, s29, v5
    v_lshlrev_b32 v4, 2, v4
    v_lshl_or_b32 v60, v5, 10, v4
    ds_add_u32 v60, v3
    v_cos_f32 v9, v9
    v_mul_hi_u32_u24 v6, s28, v61
    v_mad_i32_i24 v61, v6, s30, v61
    v_and_b32 v7, 16, v6
    v_mad_u32_u24 v7, v7, s51, v37
    v_lshl_or_b32 v37, v61, 20, v37
    v_mul_hi_u32_u24 v7, s29, v7
    v_lshlrev_b32 v6, 2, v6
    v_lshl_or_b32 v61, v7, 10, v6
    ds_add_u32 v61, v3
    v_cos_f32 v10, v10
    v_mul_hi_u32_u24 v4, s28, v62
    v_mad_i32_i24 v62, v4, s30, v62
    v_and_b32 v5, 16, v4
    v_mad_u32_u24 v5, v5, s51, v38
    v_lshl_or_b32 v38, v62, 20, v38
    v_mul_hi_u32_u24 v5, s29, v5
    v_lshlrev_b32 v4, 2, v4
    v_lshl_or_b32 v62, v5, 10, v4
    ds_add_u32 v62, v3
    v_cos_f32 v11, v11
    v_mul_hi_u32_u24 v6, s28, v63
    v_mad_i32_i24 v63, v6, s30, v63
    v_and_b32 v7, 16, v6
    v_mad_u32_u24 v7, v7, s51, v39
    v_lshl_or_b32 v39, v63, 20, v39
    v_mul_hi_u32_u24 v7, s29, v7
    v_lshlrev_b32 v6, 2, v6
    v_lshl_or_b32 v63, v7, 10, v6
    ds_add_u32 v63, v3
    v_cvt_pk_bf16_f32 v8, v8, v9
    v_cvt_pk_bf16_f32 v10, v10, v11
    v_lshl_or_b32 v60, v8, 16, v60
    v_and_or_b32 v61, v8, s31, v61
    v_lshl_or_b32 v62, v10, 16, v62
    v_and_or_b32 v63, v10, s31, v63
    s_waitcnt vmcnt(0)
    s_setprio 1
    s_add_u32 s34, s42, 16777216
    s_lshr_b32 s35, s34, 1
    s_cbranch_vccnz L_th_4
    s_waitcnt vmcnt(1)
L_th_4:
    buffer_load_dwordx4 v[68:71], v1, s[8:11], s34 offen nt
    s_cbranch_vccnz L_th_5
    s_waitcnt vmcnt(1)
L_th_5:
    buffer_load_dwordx4 v[44:47], v1, s[4:7], s34 offen nt
    s_cbranch_vccnz L_th_6
    s_waitcnt vmcnt(1)
L_th_6:
    buffer_load_dwordx2 v[22:23], v2, s[12:15], s35 offen nt
    s_waitcnt vmcnt(3)
    v_lshlrev_b32 v8, 16, v20
    v_and_b32 v9, s31, v20
    v_lshlrev_b32 v10, 16, v21
    v_and_b32 v11, s31, v21
    v_pk_mul_f32 v[8:9], v[8:9], s[32:33]
    v_pk_mul_f32 v[10:11], v[10:11], s[32:33]
    v_cvt_pk_bf16_f32 v8, 0, v8
    v_cvt_pk_bf16_f32 v9, 0, v9
    v_cvt_pk_bf16_f32 v10, 0, v10
    v_cvt_pk_bf16_f32 v11, 0, v11
    v_mul_f32 v4, s100, v8
    v_mul_f32 v5, s100, v9
    v_mul_f32 v6, s100, v10
    v_mul_f32 v7, s100, v11
    v_fract_f32 v4, v4
    v_fract_f32 v5, v5
    v_fract_f32 v6, v6
    v_fract_f32 v7, v7
    v_fma_f32 v8, v8, s101, v4
    v_fma_f32 v9, v9, s101, v5
    v_fma_f32 v10, v10, s101, v6
    v_fma_f32 v11, v11, s101, v7
    v_fract_f32 v8, v8
    v_fract_f32 v9, v9
    v_fract_f32 v10, v10
    v_fract_f32 v11, v11
    v_cos_f32 v8, v8
    v_mul_hi_u32_u24 v4, s28, v64
    v_mad_i32_i24 v64, v4, s30, v64
    v_and_b32 v5, 16, v4
    v_mad_u32_u24 v5, v5, s51, v40
    v_lshl_or_b32 v40, v64, 20, v40
    v_mul_hi_u32_u24 v5, s29, v5
    v_lshlrev_b32 v4, 2, v4
    v_lshl_or_b32 v64, v5, 10, v4
    ds_add_u32 v64, v3
    v_cos_f32 v9, v9
    v_mul_hi_u32_u24 v6, s28, v65
    v_mad_i32_i24 v65, v6, s30, v65
    v_and_b32 v7, 16, v6
    v_mad_u32_u24 v7, v7, s51, v41
    v_lshl_or_b32 v41, v65, 20, v41
    v_mul_hi_u32_u24 v7, s29, v7
    v_lshlrev_b32 v6, 2, v6
    v_lshl_or_b32 v65, v7, 10, v6
    ds_add_u32 v65, v3
    v_cos_f32 v10, v10
    v_mul_hi_u32_u24 v4, s28, v66
    v_mad_i32_i24 v66, v4, s30, v66
    v_and_b32 v5, 16, v4
    v_mad_u32_u24 v5, v5, s51, v42
    v_lshl_or_b32 v42, v66, 20, v42
    v_mul_hi_u32_u24 v5, s29, v5
    v_lshlrev_b32 v4, 2, v4
    v_lshl_or_b32 v66, v5, 10, v4
    ds_add_u32 v66, v3
    v_cos_f32 v11, v11
    v_mul_hi_u32_u24 v6, s28, v67
    v_mad_i32_i24 v67, v6, s30, v67
    v_and_b32 v7, 16, v6
    v_mad_u32_u24 v7, v7, s51, v43
    v_lshl_or_b32 v43, v67, 20, v43
    v_mul_hi_u32_u24 v7, s29, v7
    v_lshlrev_b32 v6, 2, v6
    v_lshl_or_b32 v67, v7, 10, v6
    ds_add_u32 v67, v3
    v_cvt_pk_bf16_f32 v8, v8, v9
    v_cvt_pk_bf16_f32 v10, v10, v11
    v_lshl_or_b32 v64, v8, 16, v64
    v_and_or_b32 v65, v8, s31, v65
    v_lshl_or_b32 v66, v10, 16, v66
    v_and_or_b32 v67, v10, s31, v67
    s_waitcnt vmcnt(0)
    s_add_u32 s34, s42, 20971520
    s_lshr_b32 s35, s34, 1
    s_cbranch_vccnz L_th_7
    s_waitcnt vmcnt(0)
L_th_7:
    buffer_load_dwordx4 v[72:75], v1, s[8:11], s34 offen nt
    s_cbranch_vccnz L_th_8
    s_waitcnt vmcnt(0)
L_th_8:
    buffer_load_dwordx4 v[48:51], v1, s[4:7], s34 offen nt
    s_cbranch_vccnz L_th_9
    s_waitcnt vmcnt(0)
L_th_9:
    buffer_load_dwordx2 v[24:25], v2, s[12:15], s35 offen nt
    s_waitcnt vmcnt(3)
    v_lshlrev_b32 v8, 16, v22
    v_and_b32 v9, s31, v22
    v_lshlrev_b32 v10, 16, v23
    v_and_b32 v11, s31, v23
    v_pk_mul_f32 v[8:9], v[8:9], s[32:33]
    v_pk_mul_f32 v[10:11], v[10:11], s[32:33]
    v_cvt_pk_bf16_f32 v8, 0, v8
    v_cvt_pk_bf16_f32 v9, 0, v9
    v_cvt_pk_bf16_f32 v10, 0, v10
    v_cvt_pk_bf16_f32 v11, 0, v11
    v_mul_f32 v4, s100, v8
    v_mul_f32 v5, s100, v9
    v_mul_f32 v6, s100, v10
    v_mul_f32 v7, s100, v11
    v_fract_f32 v4, v4
    v_fract_f32 v5, v5
    v_fract_f32 v6, v6
    v_fract_f32 v7, v7
    v_fma_f32 v8, v8, s101, v4
    v_fma_f32 v9, v9, s101, v5
    v_fma_f32 v10, v10, s101, v6
    v_fma_f32 v11, v11, s101, v7
    v_fract_f32 v8, v8
    v_fract_f32 v9, v9
    v_fract_f32 v10, v10
    v_fract_f32 v11, v11
    v_cos_f32 v8, v8
    v_mul_hi_u32_u24 v4, s28, v68
    v_mad_i32_i24 v68, v4, s30, v68
    v_and_b32 v5, 16, v4
    v_mad_u32_u24 v5, v5, s51, v44
    v_lshl_or_b32 v44, v68, 20, v44
    v_mul_hi_u32_u24 v5, s29, v5
    v_lshlrev_b32 v4, 2, v4
    v_lshl_or_b32 v68, v5, 10, v4
    ds_add_u32 v68, v3
    v_cos_f32 v9, v9
    v_mul_hi_u32_u24 v6, s28, v69
    v_mad_i32_i24 v69, v6, s30, v69
    v_and_b32 v7, 16, v6
    v_mad_u32_u24 v7, v7, s51, v45
    v_lshl_or_b32 v45, v69, 20, v45
    v_mul_hi_u32_u24 v7, s29, v7
    v_lshlrev_b32 v6, 2, v6
    v_lshl_or_b32 v69, v7, 10, v6
    ds_add_u32 v69, v3
    v_cos_f32 v10, v10
    v_mul_hi_u32_u24 v4, s28, v70
    v_mad_i32_i24 v70, v4, s30, v70
    v_and_b32 v5, 16, v4
    v_mad_u32_u24 v5, v5, s51, v46
    v_lshl_or_b32 v46, v70, 20, v46
    v_mul_hi_u32_u24 v5, s29, v5
    v_lshlrev_b32 v4, 2, v4
    v_lshl_or_b32 v70, v5, 10, v4
    ds_add_u32 v70, v3
    v_cos_f32 v11, v11
    v_mul_hi_u32_u24 v6, s28, v71
    v_mad_i32_i24 v71, v6, s30, v71
    v_and_b32 v7, 16, v6
    v_mad_u32_u24 v7, v7, s51, v47
    v_lshl_or_b32 v47, v71, 20, v47
    v_mul_hi_u32_u24 v7, s29, v7
    v_lshlrev_b32 v6, 2, v6
    v_lshl_or_b32 v71, v7, 10, v6
    ds_add_u32 v71, v3
    v_cvt_pk_bf16_f32 v8, v8, v9
    v_cvt_pk_bf16_f32 v10, v10, v11
    v_lshl_or_b32 v68, v8, 16, v68
    v_and_or_b32 v69, v8, s31, v69
    v_lshl_or_b32 v70, v10, 16, v70
    v_and_or_b32 v71, v10, s31, v71
    s_waitcnt vmcnt(0)
    s_add_u32 s34, s43, 50331648
    s_lshr_b32 s35, s34, 1
    v_lshlrev_b32 v125, 2, v0
    v_mov_b32 v124, 0x40000000
    v_cndmask_b32 v124, v124, v125, s[36:37]
    v_lshrrev_b32 v26, 1, v124
    buffer_load_dword v125, v124, s[8:11], s34 offen nt
    buffer_load_dword v124, v124, s[4:7], s34 offen nt
    buffer_load_ushort v26, v26, s[12:15], s35 offen nt
    s_setprio 0
    s_add_u32 s34, s42, 25165824
    s_lshr_b32 s35, s34, 1
    buffer_load_dwordx4 v[100:103], v1, s[8:11], s34 offen nt
    buffer_load_dwordx4 v[76:79], v1, s[4:7], s34 offen nt
    s_waitcnt vmcnt(5)
    v_lshlrev_b32 v8, 16, v24
    v_and_b32 v9, s31, v24
    v_lshlrev_b32 v10, 16, v25
    v_and_b32 v11, s31, v25
    v_pk_mul_f32 v[8:9], v[8:9], s[32:33]
    v_pk_mul_f32 v[10:11], v[10:11], s[32:33]
    v_cvt_pk_bf16_f32 v8, 0, v8
    v_cvt_pk_bf16_f32 v9, 0, v9
    v_cvt_pk_bf16_f32 v10, 0, v10
    v_cvt_pk_bf16_f32 v11, 0, v11
    v_mul_f32 v4, s100, v8
    v_mul_f32 v5, s100, v9
    v_mul_f32 v6, s100, v10
    v_mul_f32 v7, s100, v11
    v_fract_f32 v4, v4
    v_fract_f32 v5, v5
    v_fract_f32 v6, v6
    v_fract_f32 v7, v7
    v_fma_f32 v8, v8, s101, v4
    v_fma_f32 v9, v9, s101, v5
    v_fma_f32 v10, v10, s101, v6
    v_fma_f32 v11, v11, s101, v7
    v_fract_f32 v8, v8
    v_fract_f32 v9, v9
    v_fract_f32 v10, v10
    v_fract_f32 v11, v11
    v_cos_f32 v8, v8
    v_mul_hi_u32_u24 v4, s28, v72
    v_mad_i32_i24 v72, v4, s30, v72
    v_and_b32 v5, 16, v4
    v_mad_u32_u24 v5, v5, s51, v48
    v_lshl_or_b32 v48, v72, 20, v48
    v_mul_hi_u32_u24 v5, s29, v5
    v_lshlrev_b32 v4, 2, v4
    v_lshl_or_b32 v72, v5, 10, v4
    ds_add_u32 v72, v3
    v_cos_f32 v9, v9
    v_mul_hi_u32_u24 v6, s28, v73
    v_mad_i32_i24 v73, v6, s30, v73
    v_and_b32 v7, 16, v6
    v_mad_u32_u24 v7, v7, s51, v49
    v_lshl_or_b32 v49, v73, 20, v49
    v_mul_hi_u32_u24 v7, s29, v7
    v_lshlrev_b32 v6, 2, v6
    v_lshl_or_b32 v73, v7, 10, v6
    ds_add_u32 v73, v3
    v_cos_f32 v10, v10
    v_mul_hi_u32_u24 v4, s28, v74
    v_mad_i32_i24 v74, v4, s30, v74
    v_and_b32 v5, 16, v4
    v_mad_u32_u24 v5, v5, s51, v50
    v_lshl_or_b32 v50, v74, 20, v50
    v_mul_hi_u32_u24 v5, s29, v5
    v_lshlrev_b32 v4, 2, v4
    v_lshl_or_b32 v74, v5, 10, v4
    ds_add_u32 v74, v3
    v_cos_f32 v11, v11
    v_mul_hi_u32_u24 v6, s28, v75
    v_mad_i32_i24 v75, v6, s30, v75
    v_and_b32 v7, 16, v6
    v_mad_u32_u24 v7, v7, s51, v51
    v_lshl_or_b32 v51, v75, 20, v51
    v_mul_hi_u32_u24 v7, s29, v7
    v_lshlrev_b32 v6, 2, v6
    v_lshl_or_b32 v75, v7, 10, v6
    ds_add_u32 v75, v3
    v_cvt_pk_bf16_f32 v8, v8, v9
    v_cvt_pk_bf16_f32 v10, v10, v11
    v_lshl_or_b32 v72, v8, 16, v72
    v_and_or_b32 v73, v8, s31, v73
    v_lshl_or_b32 v74, v10, 16, v74
    v_and_or_b32 v75, v10, s31, v75
    s_waitcnt vmcnt(2)
    s_waitcnt vmcnt(2)
    s_mov_b64 exec, s[36:37]
    v_lshlrev_b32 v8, 16, v26
    v_mul_f32 v8, s32, v8
    v_cvt_pk_bf16_f32 v8, 0, v8
    v_mul_f32 v4, s100, v8
    v_fract_f32 v4, v4
    v_fma_f32 v8, v8, s101, v4
    v_fract_f32 v8, v8
    v_cos_f32 v8, v8
    v_mul_hi_u32_u24 v4, s28, v125
    v_mad_i32_i24 v125, v4, s30, v125
    v_and_b32 v5, 16, v4
    v_mad_u32_u24 v5, v5, s51, v124
    v_lshl_or_b32 v124, v125, 20, v124
    v_mul_hi_u32_u24 v5, s29, v5
    v_lshlrev_b32 v4, 2, v4
    v_lshl_or_b32 v125, v5, 10, v4
    ds_add_u32 v125, v3
    v_cvt_pk_bf16_f32 v8, v8, v8
    v_and_or_b32 v125, v8, s31, v125
    s_mov_b64 exec, -1
    s_mov_b32 s92, 3
    s_waitcnt lgkmcnt(0)
L_pf_10:
    s_barrier
    s_cmp_ge_u32 s38, 6
    s_cbranch_scc1 L_pf_11
    ds_read_b128 v[4:7], v1
    s_waitcnt lgkmcnt(0)
    v_and_b32 v8, 2, v4
    v_and_b32 v9, 2, v5
    v_and_b32 v10, 2, v6
    v_and_b32 v11, 2, v7
    v_mad_u32_u24 v4, v8, s92, v4
    v_mad_u32_u24 v5, v9, s92, v5
    v_mad_u32_u24 v6, v10, s92, v6
    v_mad_u32_u24 v7, v11, s92, v7
    v_add_u32 v5, v4, v5
    v_add_u32 v6, v5, v6
    v_add_u32 v7, v6, v7
    v_mov_b32 v8, v7
    s_nop 1
    v_add_u32_dpp v8, v8, v8 row_shr:1 row_mask:0xf bank_mask:0xf
    s_nop 1
    v_add_u32_dpp v8, v8, v8 row_shr:2 row_mask:0xf bank_mask:0xf
    s_nop 1
    v_add_u32_dpp v8, v8, v8 row_shr:4 row_mask:0xf bank_mask:0xf
    s_nop 1
    v_add_u32_dpp v8, v8, v8 row_shr:8 row_mask:0xf bank_mask:0xf
    s_nop 1
    v_add_u32_dpp v8, v8, v8 row_bcast:15 row_mask:0xa bank_mask:0xf
    s_nop 1
    v_add_u32_dpp v8, v8, v8 row_bcast:31 row_mask:0xc bank_mask:0xf
    s_nop 0
    v_readlane_b32 s45, v8, 63
    s_lshl_b32 s46, s38, 2
    v_mov_b32 v10, s46
    v_mov_b32 v9, s45
    ds_write_b32 v10, v9 offset:6144
    s_waitcnt lgkmcnt(0)
L_pf_11:
    v_and_b32 v10, 15, v0
    v_lshlrev_b32 v9, 2, v10
    s_barrier
    ds_read_b32 v9, v9 offset:6144
    s_cmp_eq_u32 s92, 0
    s_cbranch_scc1 L_pf_13
    s_setprio 3
    s_add_u32 s34, s42, 29360128
    s_lshr_b32 s35, s34, 1
    buffer_load_dwordx4 v[104:107], v1, s[8:11], s34 offen nt
    buffer_load_dwordx4 v[80:83], v1, s[4:7], s34 offen nt
L_pf_13:
    s_sub_u32 s46, s38, 1
    s_waitcnt lgkmcnt(0)
    v_add_u32_dpp v9, v9, v9 row_shr:1 row_mask:0xf bank_mask:0xf
    s_nop 1
    v_add_u32_dpp v9, v9, v9 row_shr:2 row_mask:0xf bank_mask:0xf
    s_nop 1
    v_add_u32_dpp v9, v9, v9 row_shr:4 row_mask:0xf bank_mask:0xf
    s_nop 0
    v_readlane_b32 s47, v9, 5
    s_cmp_gt_u32 s47, 157632
    s_cselect_b32 s92, 0, s92
    s_cbranch_scc1 L_pf_10
    s_cmp_ge_u32 s38, 6
    s_cbranch_scc1 L_pf_12
    v_readlane_b32 s45, v9, s46
    v_sub_u32 v8, v8, v7
    s_cmp_eq_u32 s38, 0
    s_cselect_b32 s45, 0, s45
    v_mov_b32 v12, -1
    v_add_u32 v8, s45, v8
    v_add_u32 v9, v8, v4
    v_add_u32 v10, v8, v5
    v_add_u32 v11, v8, v6
    v_add_u32 v7, v8, v7
    ds_write_b128 v1, v[8:11]
    s_cmp_eq_u32 s92, 0
    s_cbranch_scc1 L_pf_14
    ds_write_b32 v9, v12 offset:6204
    ds_write_b32 v10, v12 offset:6204
    ds_write_b32 v11, v12 offset:6204
    ds_write_b32 v7, v12 offset:6204
L_pf_14:
    s_waitcnt lgkmcnt(0)
L_pf_12:
    s_barrier
    v_and_b32 v4, 0xffff, v52
    ds_add_rtn_u32 v4, v4, v3
    v_and_b32 v5, 0xffff, v53
    ds_add_rtn_u32 v5, v5, v3
    v_and_b32 v6, 0xffff, v54
    ds_add_rtn_u32 v6, v6, v3
    v_and_b32 v7, 0xffff, v55
    ds_add_rtn_u32 v7, v7, v3
    v_and_b32 v8, 0xffff, v56
    ds_add_rtn_u32 v8, v8, v3
    v_and_b32 v9, 0xffff, v57
    ds_add_rtn_u32 v9, v9, v3
    v_and_b32 v10, 0xffff, v58
    ds_add_rtn_u32 v10, v10, v3
    v_and_b32 v11, 0xffff, v59
    ds_add_rtn_u32 v11, v11, v3
    s_waitcnt lgkmcnt(7)
    v_and_b32 v12, 2, v4
    v_mad_i32_i24 v27, v12, -2, v4
    v_add_u32 v4, v4, v12
    ds_write_b16_d16_hi v27, v52 offset:6212
    ds_write_b32 v4, v28 offset:6208
    s_waitcnt lgkmcnt(8)
    v_and_b32 v12, 2, v5
    v_mad_i32_i24 v13, v12, -2, v5
    v_add_u32 v5, v5, v12
    ds_write_b16_d16_hi v13, v53 offset:6212
    ds_write_b32 v5, v29 offset:6208
    s_waitcnt lgkmcnt(9)
    v_and_b32 v12, 2, v6
    v_mad_i32_i24 v27, v12, -2, v6
    v_add_u32 v6, v6, v12
    ds_write_b16_d16_hi v27, v54 offset:6212
    ds_write_b32 v6, v30 offset:6208
    s_waitcnt lgkmcnt(10)
    v_and_b32 v12, 2, v7
    v_mad_i32_i24 v13, v12, -2, v7
    v_add_u32 v7, v7, v12
    ds_write_b16_d16_hi v13, v55 offset:6212
    ds_write_b32 v7, v31 offset:6208
    v_and_b32 v4, 0xffff, v60
    ds_add_rtn_u32 v4, v4, v3
    v_and_b32 v5, 0xffff, v61
    ds_add_rtn_u32 v5, v5, v3
    v_and_b32 v6, 0xffff, v62
    ds_add_rtn_u32 v6, v6, v3
    v_and_b32 v7, 0xffff, v63
    ds_add_rtn_u32 v7, v7, v3
    s_setprio 2
    s_add_u32 s34, s42, 33554432
    s_lshr_b32 s35, s34, 1
    buffer_load_dwordx4 v[108:111], v1, s[8:11], s34 offen nt
    buffer_load_dwordx4 v[84:87], v1, s[4:7], s34 offen nt
    s_waitcnt lgkmcnt(15)
    v_and_b32 v12, 2, v8
    v_mad_i32_i24 v27, v12, -2, v8
    v_add_u32 v8, v8, v12
    ds_write_b16_d16_hi v27, v56 offset:6212
    ds_write_b32 v8, v32 offset:6208
    s_waitcnt lgkmcnt(15)
    v_and_b32 v12, 2, v9
    v_mad_i32_i24 v13, v12, -2, v9
    v_add_u32 v9, v9, v12
    ds_write_b16_d16_hi v13, v57 offset:6212
    ds_write_b32 v9, v33 offset:6208
    s_waitcnt lgkmcnt(15)
    v_and_b32 v12, 2, v10
    v_mad_i32_i24 v27, v12, -2, v10
    v_add_u32 v10, v10, v12
    ds_write_b16_d16_hi v27, v58 offset:6212
    ds_write_b32 v10, v34 offset:6208
    s_waitcnt lgkmcnt(15)
    v_and_b32 v12, 2, v11
    v_mad_i32_i24 v13, v12, -2, v11
    v_add_u32 v11, v11, v12
    ds_write_b16_d16_hi v13, v59 offset:6212
    ds_write_b32 v11, v35 offset:6208
    v_and_b32 v8, 0xffff, v64
    ds_add_rtn_u32 v8, v8, v3
    v_and_b32 v9, 0xffff, v65
    ds_add_rtn_u32 v9, v9, v3
    v_and_b32 v10, 0xffff, v66
    ds_add_rtn_u32 v10, v10, v3
    v_and_b32 v11, 0xffff, v67
    ds_add_rtn_u32 v11, v11, v3
    s_waitcnt lgkmcnt(15)
    v_and_b32 v12, 2, v4
    v_mad_i32_i24 v27, v12, -2, v4
    v_add_u32 v4, v4, v12
    ds_write_b16_d16_hi v27, v60 offset:6212
    ds_write_b32 v4, v36 offset:6208
    s_waitcnt lgkmcnt(15)
    v_and_b32 v12, 2, v5
    v_mad_i32_i24 v13, v12, -2, v5
    v_add_u32 v5, v5, v12
    ds_write_b16_d16_hi v13, v61 offset:6212
    ds_write_b32 v5, v37 offset:6208
    s_waitcnt lgkmcnt(15)
    v_and_b32 v12, 2, v6
    v_mad_i32_i24 v27, v12, -2, v6
    v_add_u32 v6, v6, v12
    ds_write_b16_d16_hi v27, v62 offset:6212
    ds_write_b32 v6, v38 offset:6208
    s_waitcnt lgkmcnt(15)
    v_and_b32 v12, 2, v7
    v_mad_i32_i24 v13, v12, -2, v7
    v_add_u32 v7, v7, v12
    ds_write_b16_d16_hi v13, v63 offset:6212
    ds_write_b32 v7, v39 offset:6208
    v_and_b32 v4, 0xffff, v68
    ds_add_rtn_u32 v4, v4, v3
    v_and_b32 v5, 0xffff, v69
    ds_add_rtn_u32 v5, v5, v3
    v_and_b32 v6, 0xffff, v70
    ds_add_rtn_u32 v6, v6, v3
    v_and_b32 v7, 0xffff, v71
    ds_add_rtn_u32 v7, v7, v3
    s_setprio 1
    s_add_u32 s34, s42, 37748736
    s_lshr_b32 s35, s34, 1
    buffer_load_dwordx4 v[112:115], v1, s[8:11], s34 offen nt
    buffer_load_dwordx4 v[88:91], v1, s[4:7], s34 offen nt
    s_waitcnt lgkmcnt(15)
    v_and_b32 v12, 2, v8
    v_mad_i32_i24 v27, v12, -2, v8
    v_add_u32 v8, v8, v12
    ds_write_b16_d16_hi v27, v64 offset:6212
    ds_write_b32 v8, v40 offset:6208
    s_waitcnt lgkmcnt(15)
    v_and_b32 v12, 2, v9
    v_mad_i32_i24 v13, v12, -2, v9
    v_add_u32 v9, v9, v12
    ds_write_b16_d16_hi v13, v65 offset:6212
    ds_write_b32 v9, v41 offset:6208
    s_waitcnt lgkmcnt(15)
    v_and_b32 v12, 2, v10
    v_mad_i32_i24 v27, v12, -2, v10
    v_add_u32 v10, v10, v12
    ds_write_b16_d16_hi v27, v66 offset:6212
    ds_write_b32 v10, v42 offset:6208
    s_waitcnt lgkmcnt(15)
    v_and_b32 v12, 2, v11
    v_mad_i32_i24 v13, v12, -2, v11
    v_add_u32 v11, v11, v12
    ds_write_b16_d16_hi v13, v67 offset:6212
    ds_write_b32 v11, v43 offset:6208
    v_and_b32 v8, 0xffff, v72
    ds_add_rtn_u32 v8, v8, v3
    v_and_b32 v9, 0xffff, v73
    ds_add_rtn_u32 v9, v9, v3
    v_and_b32 v10, 0xffff, v74
    ds_add_rtn_u32 v10, v10, v3
    v_and_b32 v11, 0xffff, v75
    ds_add_rtn_u32 v11, v11, v3
    s_waitcnt lgkmcnt(15)
    v_and_b32 v12, 2, v4
    v_mad_i32_i24 v27, v12, -2, v4
    v_add_u32 v4, v4, v12
    ds_write_b16_d16_hi v27, v68 offset:6212
    ds_write_b32 v4, v44 offset:6208
    s_waitcnt lgkmcnt(15)
    v_and_b32 v12, 2, v5
    v_mad_i32_i24 v13, v12, -2, v5
    v_add_u32 v5, v5, v12
    ds_write_b16_d16_hi v13, v69 offset:6212
    ds_write_b32 v5, v45 offset:6208
    s_waitcnt lgkmcnt(15)
    v_and_b32 v12, 2, v6
    v_mad_i32_i24 v27, v12, -2, v6
    v_add_u32 v6, v6, v12
    ds_write_b16_d16_hi v27, v70 offset:6212
    ds_write_b32 v6, v46 offset:6208
    s_waitcnt lgkmcnt(15)
    v_and_b32 v12, 2, v7
    v_mad_i32_i24 v13, v12, -2, v7
    v_add_u32 v7, v7, v12
    ds_write_b16_d16_hi v13, v71 offset:6212
    ds_write_b32 v7, v47 offset:6208
    s_mov_b64 exec, s[36:37]
    v_and_b32 v4, 0xffff, v125
    ds_add_rtn_u32 v4, v4, v3
    s_mov_b64 exec, -1
    s_setprio 0
    s_add_u32 s34, s42, 41943040
    s_lshr_b32 s35, s34, 1
    buffer_load_dwordx4 v[116:119], v1, s[8:11], s34 offen nt
    buffer_load_dwordx4 v[92:95], v1, s[4:7], s34 offen nt
    s_waitcnt lgkmcnt(11)
    v_and_b32 v12, 2, v8
    v_mad_i32_i24 v27, v12, -2, v8
    v_add_u32 v8, v8, v12
    ds_write_b16_d16_hi v27, v72 offset:6212
    ds_write_b32 v8, v48 offset:6208
    s_waitcnt lgkmcnt(12)
    v_and_b32 v12, 2, v9
    v_mad_i32_i24 v13, v12, -2, v9
    v_add_u32 v9, v9, v12
    ds_write_b16_d16_hi v13, v73 offset:6212
    ds_write_b32 v9, v49 offset:6208
    s_waitcnt lgkmcnt(13)
    v_and_b32 v12, 2, v10
    v_mad_i32_i24 v27, v12, -2, v10
    v_add_u32 v10, v10, v12
    ds_write_b16_d16_hi v27, v74 offset:6212
    ds_write_b32 v10, v50 offset:6208
    s_waitcnt lgkmcnt(14)
    v_and_b32 v12, 2, v11
    v_mad_i32_i24 v13, v12, -2, v11
    v_add_u32 v11, v11, v12
    ds_write_b16_d16_hi v13, v75 offset:6212
    ds_write_b32 v11, v51 offset:6208
    s_mov_b64 exec, s[36:37]
    s_waitcnt lgkmcnt(8)
    v_and_b32 v12, 2, v4
    v_mad_i32_i24 v27, v12, -2, v4
    v_add_u32 v4, v4, v12
    ds_write_b16_d16_hi v27, v125 offset:6212
    ds_write_b32 v4, v124 offset:6208
    s_mov_b64 exec, -1
    s_add_u32 s45, s2, 0
    s_mul_i32 s46, s45, 157696
    s_add_u32 s46, s46, 4096
    s_add_u32 s16, s24, s46
    s_addc_u32 s17, s25, 0
    s_min_u32 s18, s47, 157696
    s_mul_i32 s46, s45, 3072
    s_add_u32 s46, s46, 80744448
    s_add_u32 s20, s24, s46
    s_addc_u32 s21, s25, 0
    v_mul_u32_u24 v4, 21846, v0
    v_lshrrev_b32 v4, 16, v4
    v_mad_i32_i24 v7, v4, -3, v0
    v_lshlrev_b32 v4, 2, v4
    v_lshl_add_u32 v4, v7, 11, v4
    v_mov_b32 v6, 0
    v_add_u32 v12, 49152, v1
    v_add_u32 v13, 98304, v1
    v_add_u32 v27, 147456, v1
    s_waitcnt lgkmcnt(0)
    s_barrier
    ds_read_b128 v[28:31], v1 offset:6208
    ds_read_b128 v[32:35], v1 offset:22592
    ds_read_b128 v[36:39], v1 offset:38976
    ds_read_b128 v[40:43], v12 offset:6208
    ds_read_b128 v[44:47], v12 offset:22592
    ds_read_b128 v[48:51], v12 offset:38976
    ds_read_b128 v[52:55], v13 offset:6208
    ds_read_b128 v[56:59], v13 offset:22592
    ds_read_b128 v[60:63], v13 offset:38976
    ds_read_b128 v[64:67], v27 offset:6208
    s_cmp_lt_u32 s38, 12
    s_cselect_b64 exec, -1, 0
    ds_wrxchg2st64_rtn_b32 v[8:9], v4, v6, v6 offset0:0 offset1:4
    s_mov_b64 exec, -1
    s_waitcnt lgkmcnt(0)
    s_barrier
    s_cmp_eq_u32 s92, 0
    s_cselect_b32 s45, 0, 0x10001
    v_mul_hi_u32 v8, v8, s40
    v_mul_hi_u32 v9, v9, s40
    v_lshlrev_b32 v4, 2, v0
    v_lshl_or_b32 v8, v9, 16, v8
    v_add_u32 v8, s45, v8
    v_bfi_b32 v8, s45, 0, v8
    buffer_store_dword v8, v4, s[20:23], 0 offen sc1
    s_setprio 3
    s_add_u32 s34, s42, 46137344
    s_lshr_b32 s35, s34, 1
    buffer_load_dwordx4 v[120:123], v1, s[8:11], s34 offen nt
    buffer_load_dwordx4 v[96:99], v1, s[4:7], s34 offen nt
    s_add_u32 s34, s43, 50765824
    s_lshr_b32 s35, s34, 1
    v_lshlrev_b32 v127, 2, v0
    v_mov_b32 v126, 0x40000000
    v_cndmask_b32 v126, v126, v127, s[36:37]
    v_lshrrev_b32 v26, 1, v126
    buffer_load_dword v127, v126, s[8:11], s34 offen nt
    buffer_load_dword v126, v126, s[4:7], s34 offen nt
    buffer_load_ushort v26, v26, s[12:15], s35 offen nt
    s_waitcnt vmcnt(14)
    v_mul_hi_u32_u24 v4, s28, v100
    v_mad_i32_i24 v100, v4, s30, v100
    v_and_b32 v5, 16, v4
    v_mad_u32_u24 v5, v5, s51, v76
    v_lshl_or_b32 v76, v100, 20, v76
    v_mul_hi_u32_u24 v5, s29, v5
    v_lshlrev_b32 v4, 2, v4
    v_lshl_or_b32 v100, v5, 10, v4
    ds_add_u32 v100, v3
    v_mul_hi_u32_u24 v6, s28, v101
    v_mad_i32_i24 v101, v6, s30, v101
    v_and_b32 v7, 16, v6
    v_mad_u32_u24 v7, v7, s51, v77
    v_lshl_or_b32 v77, v101, 20, v77
    v_mul_hi_u32_u24 v7, s29, v7
    v_lshlrev_b32 v6, 2, v6
    v_lshl_or_b32 v101, v7, 10, v6
    ds_add_u32 v101, v3
    v_mul_hi_u32_u24 v4, s28, v102
    v_mad_i32_i24 v102, v4, s30, v102
    v_and_b32 v5, 16, v4
    v_mad_u32_u24 v5, v5, s51, v78
    v_lshl_or_b32 v78, v102, 20, v78
    v_mul_hi_u32_u24 v5, s29, v5
    v_lshlrev_b32 v4, 2, v4
    v_lshl_or_b32 v102, v5, 10, v4
    ds_add_u32 v102, v3
    v_mul_hi_u32_u24 v6, s28, v103
    v_mad_i32_i24 v103, v6, s30, v103
    v_and_b32 v7, 16, v6
    v_mad_u32_u24 v7, v7, s51, v79
    v_lshl_or_b32 v79, v103, 20, v79
    v_mul_hi_u32_u24 v7, s29, v7
    v_lshlrev_b32 v6, 2, v6
    v_lshl_or_b32 v103, v7, 10, v6
    ds_add_u32 v103, v3
    s_setprio 2
    s_add_u32 s34, s42, 25165824
    s_lshr_b32 s35, s34, 1
    buffer_load_dwordx2 v[14:15], v2, s[12:15], s35 offen nt
    s_add_u32 s34, s42, 29360128
    s_lshr_b32 s35, s34, 1
    buffer_load_dwordx2 v[16:17], v2, s[12:15], s35 offen nt
    s_waitcnt vmcnt(14)
    v_mul_hi_u32_u24 v4, s28, v104
    v_mad_i32_i24 v104, v4, s30, v104
    v_and_b32 v5, 16, v4
    v_mad_u32_u24 v5, v5, s51, v80
    v_lshl_or_b32 v80, v104, 20, v80
    v_mul_hi_u32_u24 v5, s29, v5
    v_lshlrev_b32 v4, 2, v4
    v_lshl_or_b32 v104, v5, 10, v4
    ds_add_u32 v104, v3
    v_mul_hi_u32_u24 v6, s28, v105
    v_mad_i32_i24 v105, v6, s30, v105
    v_and_b32 v7, 16, v6
    v_mad_u32_u24 v7, v7, s51, v81
    v_lshl_or_b32 v81, v105, 20, v81
    v_mul_hi_u32_u24 v7, s29, v7
    v_lshlrev_b32 v6, 2, v6
    v_lshl_or_b32 v105, v7, 10, v6
    ds_add_u32 v105, v3
    v_mul_hi_u32_u24 v4, s28, v106
    v_mad_i32_i24 v106, v4, s30, v106
    v_and_b32 v5, 16, v4
    v_mad_u32_u24 v5, v5, s51, v82
    v_lshl_or_b32 v82, v106, 20, v82
    v_mul_hi_u32_u24 v5, s29, v5
    v_lshlrev_b32 v4, 2, v4
    v_lshl_or_b32 v106, v5, 10, v4
    ds_add_u32 v106, v3
    v_mul_hi_u32_u24 v6, s28, v107
    v_mad_i32_i24 v107, v6, s30, v107
    v_and_b32 v7, 16, v6
    v_mad_u32_u24 v7, v7, s51, v83
    v_lshl_or_b32 v83, v107, 20, v83
    v_mul_hi_u32_u24 v7, s29, v7
    v_lshlrev_b32 v6, 2, v6
    v_lshl_or_b32 v107, v7, 10, v6
    ds_add_u32 v107, v3
    s_waitcnt vmcnt(12)
    v_mul_hi_u32_u24 v4, s28, v108
    v_mad_i32_i24 v108, v4, s30, v108
    v_and_b32 v5, 16, v4
    v_mad_u32_u24 v5, v5, s51, v84
    v_lshl_or_b32 v84, v108, 20, v84
    v_mul_hi_u32_u24 v5, s29, v5
    v_lshlrev_b32 v4, 2, v4
    v_lshl_or_b32 v108, v5, 10, v4
    ds_add_u32 v108, v3
    v_mul_hi_u32_u24 v6, s28, v109
    v_mad_i32_i24 v109, v6, s30, v109
    v_and_b32 v7, 16, v6
    v_mad_u32_u24 v7, v7, s51, v85
    v_lshl_or_b32 v85, v109, 20, v85
    v_mul_hi_u32_u24 v7, s29, v7
    v_lshlrev_b32 v6, 2, v6
    v_lshl_or_b32 v109, v7, 10, v6
    ds_add_u32 v109, v3
    v_mul_hi_u32_u24 v4, s28, v110
    v_mad_i32_i24 v110, v4, s30, v110
    v_and_b32 v5, 16, v4
    v_mad_u32_u24 v5, v5, s51, v86
    v_lshl_or_b32 v86, v110, 20, v86
    v_mul_hi_u32_u24 v5, s29, v5
    v_lshlrev_b32 v4, 2, v4
    v_lshl_or_b32 v110, v5, 10, v4
    ds_add_u32 v110, v3
    v_mul_hi_u32_u24 v6, s28, v111
    v_mad_i32_i24 v111, v6, s30, v111
    v_and_b32 v7, 16, v6
    v_mad_u32_u24 v7, v7, s51, v87
    v_lshl_or_b32 v87, v111, 20, v87
    v_mul_hi_u32_u24 v7, s29, v7
    v_lshlrev_b32 v6, 2, v6
    v_lshl_or_b32 v111, v7, 10, v6
    ds_add_u32 v111, v3
    s_setprio 1
    s_add_u32 s34, s42, 33554432
    s_lshr_b32 s35, s34, 1
    buffer_load_dwordx2 v[18:19], v2, s[12:15], s35 offen nt
    s_add_u32 s34, s42, 37748736
    s_lshr_b32 s35, s34, 1
    buffer_load_dwordx2 v[20:21], v2, s[12:15], s35 offen nt
    s_waitcnt vmcnt(12)
    v_mul_hi_u32_u24 v4, s28, v112
    v_mad_i32_i24 v112, v4, s30, v112
    v_and_b32 v5, 16, v4
    v_mad_u32_u24 v5, v5, s51, v88
    v_lshl_or_b32 v88, v112, 20, v88
    v_mul_hi_u32_u24 v5, s29, v5
    v_lshlrev_b32 v4, 2, v4
    v_lshl_or_b32 v112, v5, 10, v4
    ds_add_u32 v112, v3
    v_mul_hi_u32_u24 v6, s28, v113
    v_mad_i32_i24 v113, v6, s30, v113
    v_and_b32 v7, 16, v6
    v_mad_u32_u24 v7, v7, s51, v89
    v_lshl_or_b32 v89, v113, 20, v89
    v_mul_hi_u32_u24 v7, s29, v7
    v_lshlrev_b32 v6, 2, v6
    v_lshl_or_b32 v113, v7, 10, v6
    ds_add_u32 v113, v3
    v_mul_hi_u32_u24 v4, s28, v114
    v_mad_i32_i24 v114, v4, s30, v114
    v_and_b32 v5, 16, v4
    v_mad_u32_u24 v5, v5, s51, v90
    v_lshl_or_b32 v90, v114, 20, v90
    v_mul_hi_u32_u24 v5, s29, v5
    v_lshlrev_b32 v4, 2, v4
    v_lshl_or_b32 v114, v5, 10, v4
    ds_add_u32 v114, v3
    v_mul_hi_u32_u24 v6, s28, v115
    v_mad_i32_i24 v115, v6, s30, v115
    v_and_b32 v7, 16, v6
    v_mad_u32_u24 v7, v7, s51, v91
    v_lshl_or_b32 v91, v115, 20, v91
    v_mul_hi_u32_u24 v7, s29, v7
    v_lshlrev_b32 v6, 2, v6
    v_lshl_or_b32 v115, v7, 10, v6
    ds_add_u32 v115, v3
    s_waitcnt vmcnt(10)
    v_mul_hi_u32_u24 v4, s28, v116
    v_mad_i32_i24 v116, v4, s30, v116
    v_and_b32 v5, 16, v4
    v_mad_u32_u24 v5, v5, s51, v92
    v_lshl_or_b32 v92, v116, 20, v92
    v_mul_hi_u32_u24 v5, s29, v5
    v_lshlrev_b32 v4, 2, v4
    v_lshl_or_b32 v116, v5, 10, v4
    ds_add_u32 v116, v3
    v_mul_hi_u32_u24 v6, s28, v117
    v_mad_i32_i24 v117, v6, s30, v117
    v_and_b32 v7, 16, v6
    v_mad_u32_u24 v7, v7, s51, v93
    v_lshl_or_b32 v93, v117, 20, v93
    v_mul_hi_u32_u24 v7, s29, v7
    v_lshlrev_b32 v6, 2, v6
    v_lshl_or_b32 v117, v7, 10, v6
    ds_add_u32 v117, v3
    v_mul_hi_u32_u24 v4, s28, v118
    v_mad_i32_i24 v118, v4, s30, v118
    v_and_b32 v5, 16, v4
    v_mad_u32_u24 v5, v5, s51, v94
    v_lshl_or_b32 v94, v118, 20, v94
    v_mul_hi_u32_u24 v5, s29, v5
    v_lshlrev_b32 v4, 2, v4
    v_lshl_or_b32 v118, v5, 10, v4
    ds_add_u32 v118, v3
    v_mul_hi_u32_u24 v6, s28, v119
    v_mad_i32_i24 v119, v6, s30, v119
    v_and_b32 v7, 16, v6
    v_mad_u32_u24 v7, v7, s51, v95
    v_lshl_or_b32 v95, v119, 20, v95
    v_mul_hi_u32_u24 v7, s29, v7
    v_lshlrev_b32 v6, 2, v6
    v_lshl_or_b32 v119, v7, 10, v6
    ds_add_u32 v119, v3
    s_add_u32 s34, s42, 41943040
    s_lshr_b32 s35, s34, 1
    buffer_load_dwordx2 v[22:23], v2, s[12:15], s35 offen nt
    s_add_u32 s34, s42, 46137344
    s_lshr_b32 s35, s34, 1
    buffer_load_dwordx2 v[24:25], v2, s[12:15], s35 offen nt
    s_waitcnt vmcnt(9)
    v_mul_hi_u32_u24 v4, s28, v120
    v_mad_i32_i24 v120, v4, s30, v120
    v_and_b32 v5, 16, v4
    v_mad_u32_u24 v5, v5, s51, v96
    v_lshl_or_b32 v96, v120, 20, v96
    v_mul_hi_u32_u24 v5, s29, v5
    v_lshlrev_b32 v4, 2, v4
    v_lshl_or_b32 v120, v5, 10, v4
    ds_add_u32 v120, v3
    v_mul_hi_u32_u24 v6, s28, v121
    v_mad_i32_i24 v121, v6, s30, v121
    v_and_b32 v7, 16, v6
    v_mad_u32_u24 v7, v7, s51, v97
    v_lshl_or_b32 v97, v121, 20, v97
    v_mul_hi_u32_u24 v7, s29, v7
    v_lshlrev_b32 v6, 2, v6
    v_lshl_or_b32 v121, v7, 10, v6
    ds_add_u32 v121, v3
    v_mul_hi_u32_u24 v4, s28, v122
    v_mad_i32_i24 v122, v4, s30, v122
    v_and_b32 v5, 16, v4
    v_mad_u32_u24 v5, v5, s51, v98
    v_lshl_or_b32 v98, v122, 20, v98
    v_mul_hi_u32_u24 v5, s29, v5
    v_lshlrev_b32 v4, 2, v4
    v_lshl_or_b32 v122, v5, 10, v4
    ds_add_u32 v122, v3
    v_mul_hi_u32_u24 v6, s28, v123
    v_mad_i32_i24 v123, v6, s30, v123
    v_and_b32 v7, 16, v6
    v_mad_u32_u24 v7, v7, s51, v99
    v_lshl_or_b32 v99, v123, 20, v99
    v_mul_hi_u32_u24 v7, s29, v7
    v_lshlrev_b32 v6, 2, v6
    v_lshl_or_b32 v123, v7, 10, v6
    ds_add_u32 v123, v3
    s_waitcnt vmcnt(6)
    s_mov_b64 exec, s[36:37]
    v_lshlrev_b32 v8, 16, v26
    v_mul_f32 v8, s32, v8
    v_cvt_pk_bf16_f32 v8, 0, v8
    v_mul_f32 v4, s100, v8
    v_fract_f32 v4, v4
    v_fma_f32 v8, v8, s101, v4
    v_fract_f32 v8, v8
    v_cos_f32 v8, v8
    v_mul_hi_u32_u24 v4, s28, v127
    v_mad_i32_i24 v127, v4, s30, v127
    v_and_b32 v5, 16, v4
    v_mad_u32_u24 v5, v5, s51, v126
    v_lshl_or_b32 v126, v127, 20, v126
    v_mul_hi_u32_u24 v5, s29, v5
    v_lshlrev_b32 v4, 2, v4
    v_lshl_or_b32 v127, v5, 10, v4
    ds_add_u32 v127, v3
    v_cvt_pk_bf16_f32 v8, v8, v8
    v_and_or_b32 v127, v8, s31, v127
    s_mov_b64 exec, -1
    s_mov_b32 s92, 3
    s_waitcnt lgkmcnt(0)
L_pf_15:
    s_barrier
    s_cmp_ge_u32 s38, 6
    s_cbranch_scc1 L_pf_16
    ds_read_b128 v[4:7], v1
    s_waitcnt lgkmcnt(0)
    v_and_b32 v8, 2, v4
    v_and_b32 v9, 2, v5
    v_and_b32 v10, 2, v6
    v_and_b32 v11, 2, v7
    v_mad_u32_u24 v4, v8, s92, v4
    v_mad_u32_u24 v5, v9, s92, v5
    v_mad_u32_u24 v6, v10, s92, v6
    v_mad_u32_u24 v7, v11, s92, v7
    v_add_u32 v5, v4, v5
    v_add_u32 v6, v5, v6
    v_add_u32 v7, v6, v7
    v_mov_b32 v8, v7
    s_nop 1
    v_add_u32_dpp v8, v8, v8 row_shr:1 row_mask:0xf bank_mask:0xf
    s_nop 1
    v_add_u32_dpp v8, v8, v8 row_shr:2 row_mask:0xf bank_mask:0xf
    s_nop 1
    v_add_u32_dpp v8, v8, v8 row_shr:4 row_mask:0xf bank_mask:0xf
    s_nop 1
    v_add_u32_dpp v8, v8, v8 row_shr:8 row_mask:0xf bank_mask:0xf
    s_nop 1
    v_add_u32_dpp v8, v8, v8 row_bcast:15 row_mask:0xa bank_mask:0xf
    s_nop 1
    v_add_u32_dpp v8, v8, v8 row_bcast:31 row_mask:0xc bank_mask:0xf
    s_nop 0
    v_readlane_b32 s45, v8, 63
    s_lshl_b32 s46, s38, 2
    v_mov_b32 v10, s46
    v_mov_b32 v9, s45
    ds_write_b32 v10, v9 offset:6144
    s_waitcnt lgkmcnt(0)
L_pf_16:
    v_and_b32 v10, 15, v0
    v_lshlrev_b32 v9, 2, v10
    s_barrier
    ds_read_b32 v9, v9 offset:6144
    s_cmp_eq_u32 s92, 0
    s_cbranch_scc1 L_pf_18
    s_setprio 0
    s_mov_b32 s45, 0
    buffer_store_dwordx4 v[28:31], v1, s[16:19], s45 offen sc1
L_pf_18:
    s_sub_u32 s46, s38, 1
    s_waitcnt lgkmcnt(0)
    v_add_u32_dpp v9, v9, v9 row_shr:1 row_mask:0xf bank_mask:0xf
    s_nop 1
    v_add_u32_dpp v9, v9, v9 row_shr:2 row_mask:0xf bank_mask:0xf
    s_nop 1
    v_add_u32_dpp v9, v9, v9 row_shr:4 row_mask:0xf bank_mask:0xf
    s_nop 0
    v_readlane_b32 s47, v9, 5
    s_cmp_gt_u32 s47, 157632
    s_cselect_b32 s92, 0, s92
    s_cbranch_scc1 L_pf_15
    s_cmp_ge_u32 s38, 6
    s_cbranch_scc1 L_pf_17
    v_readlane_b32 s45, v9, s46
    v_sub_u32 v8, v8, v7
    s_cmp_eq_u32 s38, 0
    s_cselect_b32 s45, 0, s45
    v_mov_b32 v12, -1
    v_add_u32 v8, s45, v8
    v_add_u32 v9, v8, v4
    v_add_u32 v10, v8, v5
    v_add_u32 v11, v8, v6
    v_add_u32 v7, v8, v7
    ds_write_b128 v1, v[8:11]
    s_cmp_eq_u32 s92, 0
    s_cbranch_scc1 L_pf_19
    ds_write_b32 v9, v12 offset:6204
    ds_write_b32 v10, v12 offset:6204
    ds_write_b32 v11, v12 offset:6204
    ds_write_b32 v7, v12 offset:6204
L_pf_19:
    s_waitcnt lgkmcnt(0)
L_pf_17:
    s_barrier
    ds_add_rtn_u32 v4, v100, v3
    ds_add_rtn_u32 v5, v101, v3
    ds_add_rtn_u32 v6, v102, v3
    ds_add_rtn_u32 v7, v103, v3
    ds_add_rtn_u32 v8, v104, v3
    ds_add_rtn_u32 v9, v105, v3
    ds_add_rtn_u32 v10, v106, v3
    ds_add_rtn_u32 v11, v107, v3
    s_mov_b32 s45, 16384
    buffer_store_dwordx4 v[32:35], v1, s[16:19], s45 offen sc1
    s_mov_b32 s45, 32768
    buffer_store_dwordx4 v[36:39], v1, s[16:19], s45 offen sc1
    s_mov_b32 s45, 49152
    buffer_store_dwordx4 v[40:43], v1, s[16:19], s45 offen sc1
    s_waitcnt vmcnt(9)
    v_lshlrev_b32 v68, 16, v14
    v_and_b32 v69, s31, v14
    v_lshlrev_b32 v70, 16, v15
    v_and_b32 v71, s31, v15
    v_pk_mul_f32 v[68:69], v[68:69], s[32:33]
    v_pk_mul_f32 v[70:71], v[70:71], s[32:33]
    v_cvt_pk_bf16_f32 v68, 0, v68
    v_cvt_pk_bf16_f32 v69, 0, v69
    v_cvt_pk_bf16_f32 v70, 0, v70
    v_cvt_pk_bf16_f32 v71, 0, v71
    v_mul_f32 v72, s100, v68
    v_mul_f32 v73, s100, v69
    v_mul_f32 v74, s100, v70
    v_mul_f32 v75, s100, v71
    v_fract_f32 v72, v72
    v_fract_f32 v73, v73
    v_fract_f32 v74, v74
    v_fract_f32 v75, v75
    v_fma_f32 v68, v68, s101, v72
    v_fma_f32 v69, v69, s101, v73
    v_fma_f32 v70, v70, s101, v74
    v_fma_f32 v71, v71, s101, v75
    v_fract_f32 v68, v68
    v_fract_f32 v69, v69
    v_fract_f32 v70, v70
    v_fract_f32 v71, v71
    v_cos_f32 v68, v68
    v_cos_f32 v69, v69
    v_cos_f32 v70, v70
    v_cos_f32 v71, v71
    v_cvt_pk_bf16_f32 v14, v68, v69
    v_cvt_pk_bf16_f32 v15, v70, v71
    s_waitcnt lgkmcnt(7)
    v_and_b32 v12, 2, v4
    v_mad_i32_i24 v27, v12, -2, v4
    v_add_u32 v4, v4, v12
    ds_write_b16 v27, v14 offset:6212
    ds_write_b32 v4, v76 offset:6208
    s_waitcnt lgkmcnt(8)
    v_and_b32 v12, 2, v5
    v_mad_i32_i24 v13, v12, -2, v5
    v_add_u32 v5, v5, v12
    ds_write_b16_d16_hi v13, v14 offset:6212
    ds_write_b32 v5, v77 offset:6208
    s_waitcnt lgkmcnt(9)
    v_and_b32 v12, 2, v6
    v_mad_i32_i24 v27, v12, -2, v6
    v_add_u32 v6, v6, v12
    ds_write_b16 v27, v15 offset:6212
    ds_write_b32 v6, v78 offset:6208
    s_waitcnt lgkmcnt(10)
    v_and_b32 v12, 2, v7
    v_mad_i32_i24 v13, v12, -2, v7
    v_add_u32 v7, v7, v12
    ds_write_b16_d16_hi v13, v15 offset:6212
    ds_write_b32 v7, v79 offset:6208
    ds_add_rtn_u32 v4, v108, v3
    ds_add_rtn_u32 v5, v109, v3
    ds_add_rtn_u32 v6, v110, v3
    ds_add_rtn_u32 v7, v111, v3
    s_mov_b32 s45, 65536
    buffer_store_dwordx4 v[44:47], v1, s[16:19], s45 offen sc1
    s_mov_b32 s45, 81920
    buffer_store_dwordx4 v[48:51], v1, s[16:19], s45 offen sc1
    s_waitcnt vmcnt(10)
    v_lshlrev_b32 v68, 16, v16
    v_and_b32 v69, s31, v16
    v_lshlrev_b32 v70, 16, v17
    v_and_b32 v71, s31, v17
    v_pk_mul_f32 v[68:69], v[68:69], s[32:33]
    v_pk_mul_f32 v[70:71], v[70:71], s[32:33]
    v_cvt_pk_bf16_f32 v68, 0, v68
    v_cvt_pk_bf16_f32 v69, 0, v69
    v_cvt_pk_bf16_f32 v70, 0, v70
    v_cvt_pk_bf16_f32 v71, 0, v71
    v_mul_f32 v72, s100, v68
    v_mul_f32 v73, s100, v69
    v_mul_f32 v74, s100, v70
    v_mul_f32 v75, s100, v71
    v_fract_f32 v72, v72
    v_fract_f32 v73, v73
    v_fract_f32 v74, v74
    v_fract_f32 v75, v75
    v_fma_f32 v68, v68, s101, v72
    v_fma_f32 v69, v69, s101, v73
    v_fma_f32 v70, v70, s101, v74
    v_fma_f32 v71, v71, s101, v75
    v_fract_f32 v68, v68
    v_fract_f32 v69, v69
    v_fract_f32 v70, v70
    v_fract_f32 v71, v71
    v_cos_f32 v68, v68
    v_cos_f32 v69, v69
    v_cos_f32 v70, v70
    v_cos_f32 v71, v71
    v_cvt_pk_bf16_f32 v16, v68, v69
    v_cvt_pk_bf16_f32 v17, v70, v71
    s_waitcnt lgkmcnt(15)
    v_and_b32 v12, 2, v8
    v_mad_i32_i24 v27, v12, -2, v8
    v_add_u32 v8, v8, v12
    ds_write_b16 v27, v16 offset:6212
    ds_write_b32 v8, v80 offset:6208
    s_waitcnt lgkmcnt(15)
    v_and_b32 v12, 2, v9
    v_mad_i32_i24 v13, v12, -2, v9
    v_add_u32 v9, v9, v12
    ds_write_b16_d16_hi v13, v16 offset:6212
    ds_write_b32 v9, v81 offset:6208
    s_waitcnt lgkmcnt(15)
    v_and_b32 v12, 2, v10
    v_mad_i32_i24 v27, v12, -2, v10
    v_add_u32 v10, v10, v12
    ds_write_b16 v27, v17 offset:6212
    ds_write_b32 v10, v82 offset:6208
    s_waitcnt lgkmcnt(15)
    v_and_b32 v12, 2, v11
    v_mad_i32_i24 v13, v12, -2, v11
    v_add_u32 v11, v11, v12
    ds_write_b16_d16_hi v13, v17 offset:6212
    ds_write_b32 v11, v83 offset:6208
    ds_add_rtn_u32 v8, v112, v3
    ds_add_rtn_u32 v9, v113, v3
    ds_add_rtn_u32 v10, v114, v3
    ds_add_rtn_u32 v11, v115, v3
    s_mov_b32 s45, 98304
    buffer_store_dwordx4 v[52:55], v1, s[16:19], s45 offen sc1
    s_mov_b32 s45, 114688
    buffer_store_dwordx4 v[56:59], v1, s[16:19], s45 offen sc1
    s_waitcnt vmcnt(11)
    v_lshlrev_b32 v68, 16, v18
    v_and_b32 v69, s31, v18
    v_lshlrev_b32 v70, 16, v19
    v_and_b32 v71, s31, v19
    v_pk_mul_f32 v[68:69], v[68:69], s[32:33]
    v_pk_mul_f32 v[70:71], v[70:71], s[32:33]
    v_cvt_pk_bf16_f32 v68, 0, v68
    v_cvt_pk_bf16_f32 v69, 0, v69
    v_cvt_pk_bf16_f32 v70, 0, v70
    v_cvt_pk_bf16_f32 v71, 0, v71
    v_mul_f32 v72, s100, v68
    v_mul_f32 v73, s100, v69
    v_mul_f32 v74, s100, v70
    v_mul_f32 v75, s100, v71
    v_fract_f32 v72, v72
    v_fract_f32 v73, v73
    v_fract_f32 v74, v74
    v_fract_f32 v75, v75
    v_fma_f32 v68, v68, s101, v72
    v_fma_f32 v69, v69, s101, v73
    v_fma_f32 v70, v70, s101, v74
    v_fma_f32 v71, v71, s101, v75
    v_fract_f32 v68, v68
    v_fract_f32 v69, v69
    v_fract_f32 v70, v70
    v_fract_f32 v71, v71
    v_cos_f32 v68, v68
    v_cos_f32 v69, v69
    v_cos_f32 v70, v70
    v_cos_f32 v71, v71
    v_cvt_pk_bf16_f32 v18, v68, v69
    v_cvt_pk_bf16_f32 v19, v70, v71
    s_waitcnt lgkmcnt(15)
    v_and_b32 v12, 2, v4
    v_mad_i32_i24 v27, v12, -2, v4
    v_add_u32 v4, v4, v12
    ds_write_b16 v27, v18 offset:6212
    ds_write_b32 v4, v84 offset:6208
    s_waitcnt lgkmcnt(15)
    v_and_b32 v12, 2, v5
    v_mad_i32_i24 v13, v12, -2, v5
    v_add_u32 v5, v5, v12
    ds_write_b16_d16_hi v13, v18 offset:6212
    ds_write_b32 v5, v85 offset:6208
    s_waitcnt lgkmcnt(15)
    v_and_b32 v12, 2, v6
    v_mad_i32_i24 v27, v12, -2, v6
    v_add_u32 v6, v6, v12
    ds_write_b16 v27, v19 offset:6212
    ds_write_b32 v6, v86 offset:6208
    s_waitcnt lgkmcnt(15)
    v_and_b32 v12, 2, v7
    v_mad_i32_i24 v13, v12, -2, v7
    v_add_u32 v7, v7, v12
    ds_write_b16_d16_hi v13, v19 offset:6212
    ds_write_b32 v7, v87 offset:6208
    ds_add_rtn_u32 v4, v116, v3
    ds_add_rtn_u32 v5, v117, v3
    ds_add_rtn_u32 v6, v118, v3
    ds_add_rtn_u32 v7, v119, v3
    s_mov_b32 s45, 131072
    buffer_store_dwordx4 v[60:63], v1, s[16:19], s45 offen sc1
    s_waitcnt vmcnt(11)
    v_lshlrev_b32 v68, 16, v20
    v_and_b32 v69, s31, v20
    v_lshlrev_b32 v70, 16, v21
    v_and_b32 v71, s31, v21
    v_pk_mul_f32 v[68:69], v[68:69], s[32:33]
    v_pk_mul_f32 v[70:71], v[70:71], s[32:33]
    v_cvt_pk_bf16_f32 v68, 0, v68
    v_cvt_pk_bf16_f32 v69, 0, v69
    v_cvt_pk_bf16_f32 v70, 0, v70
    v_cvt_pk_bf16_f32 v71, 0, v71
    v_mul_f32 v72, s100, v68
    v_mul_f32 v73, s100, v69
    v_mul_f32 v74, s100, v70
    v_mul_f32 v75, s100, v71
    v_fract_f32 v72, v72
    v_fract_f32 v73, v73
    v_fract_f32 v74, v74
    v_fract_f32 v75, v75
    v_fma_f32 v68, v68, s101, v72
    v_fma_f32 v69, v69, s101, v73
    v_fma_f32 v70, v70, s101, v74
    v_fma_f32 v71, v71, s101, v75
    v_fract_f32 v68, v68
    v_fract_f32 v69, v69
    v_fract_f32 v70, v70
    v_fract_f32 v71, v71
    v_cos_f32 v68, v68
    v_cos_f32 v69, v69
    v_cos_f32 v70, v70
    v_cos_f32 v71, v71
    v_cvt_pk_bf16_f32 v20, v68, v69
    v_cvt_pk_bf16_f32 v21, v70, v71
    s_waitcnt lgkmcnt(15)
    v_and_b32 v12, 2, v8
    v_mad_i32_i24 v27, v12, -2, v8
    v_add_u32 v8, v8, v12
    ds_write_b16 v27, v20 offset:6212
    ds_write_b32 v8, v88 offset:6208
    s_waitcnt lgkmcnt(15)
    v_and_b32 v12, 2, v9
    v_mad_i32_i24 v13, v12, -2, v9
    v_add_u32 v9, v9, v12
    ds_write_b16_d16_hi v13, v20 offset:6212
    ds_write_b32 v9, v89 offset:6208
    s_waitcnt lgkmcnt(15)
    v_and_b32 v12, 2, v10
    v_mad_i32_i24 v27, v12, -2, v10
    v_add_u32 v10, v10, v12
    ds_write_b16 v27, v21 offset:6212
    ds_write_b32 v10, v90 offset:6208
    s_waitcnt lgkmcnt(15)
    v_and_b32 v12, 2, v11
    v_mad_i32_i24 v13, v12, -2, v11
    v_add_u32 v11, v11, v12
    ds_write_b16_d16_hi v13, v21 offset:6212
    ds_write_b32 v11, v91 offset:6208
    ds_add_rtn_u32 v8, v120, v3
    ds_add_rtn_u32 v9, v121, v3
    ds_add_rtn_u32 v10, v122, v3
    ds_add_rtn_u32 v11, v123, v3
    s_mov_b32 s45, 147456
    buffer_store_dwordx4 v[64:67], v1, s[16:19], s45 offen sc1
    s_waitcnt vmcnt(11)
    v_lshlrev_b32 v68, 16, v22
    v_and_b32 v69, s31, v22
    v_lshlrev_b32 v70, 16, v23
    v_and_b32 v71, s31, v23
    v_pk_mul_f32 v[68:69], v[68:69], s[32:33]
    v_pk_mul_f32 v[70:71], v[70:71], s[32:33]
    v_cvt_pk_bf16_f32 v68, 0, v68
    v_cvt_pk_bf16_f32 v69, 0, v69
    v_cvt_pk_bf16_f32 v70, 0, v70
    v_cvt_pk_bf16_f32 v71, 0, v71
    v_mul_f32 v72, s100, v68
    v_mul_f32 v73, s100, v69
    v_mul_f32 v74, s100, v70
    v_mul_f32 v75, s100, v71
    v_fract_f32 v72, v72
    v_fract_f32 v73, v73
    v_fract_f32 v74, v74
    v_fract_f32 v75, v75
    v_fma_f32 v68, v68, s101, v72
    v_fma_f32 v69, v69, s101, v73
    v_fma_f32 v70, v70, s101, v74
    v_fma_f32 v71, v71, s101, v75
    v_fract_f32 v68, v68
    v_fract_f32 v69, v69
    v_fract_f32 v70, v70
    v_fract_f32 v71, v71
    v_cos_f32 v68, v68
    v_cos_f32 v69, v69
    v_cos_f32 v70, v70
    v_cos_f32 v71, v71
    v_cvt_pk_bf16_f32 v22, v68, v69
    v_cvt_pk_bf16_f32 v23, v70, v71
    s_waitcnt lgkmcnt(15)
    v_and_b32 v12, 2, v4
    v_mad_i32_i24 v27, v12, -2, v4
    v_add_u32 v4, v4, v12
    ds_write_b16 v27, v22 offset:6212
    ds_write_b32 v4, v92 offset:6208
    s_waitcnt lgkmcnt(15)
    v_and_b32 v12, 2, v5
    v_mad_i32_i24 v13, v12, -2, v5
    v_add_u32 v5, v5, v12
    ds_write_b16_d16_hi v13, v22 offset:6212
    ds_write_b32 v5, v93 offset:6208
    s_waitcnt lgkmcnt(15)
    v_and_b32 v12, 2, v6
    v_mad_i32_i24 v27, v12, -2, v6
    v_add_u32 v6, v6, v12
    ds_write_b16 v27, v23 offset:6212
    ds_write_b32 v6, v94 offset:6208
    s_waitcnt lgkmcnt(15)
    v_and_b32 v12, 2, v7
    v_mad_i32_i24 v13, v12, -2, v7
    v_add_u32 v7, v7, v12
    ds_write_b16_d16_hi v13, v23 offset:6212
    ds_write_b32 v7, v95 offset:6208
    s_mov_b64 exec, s[36:37]
    v_and_b32 v4, 0xffff, v127
    ds_add_rtn_u32 v4, v4, v3
    s_mov_b64 exec, -1
    s_waitcnt vmcnt(10)
    v_lshlrev_b32 v68, 16, v24
    v_and_b32 v69, s31, v24
    v_lshlrev_b32 v70, 16, v25
    v_and_b32 v71, s31, v25
    v_pk_mul_f32 v[68:69], v[68:69], s[32:33]
    v_pk_mul_f32 v[70:71], v[70:71], s[32:33]
    v_cvt_pk_bf16_f32 v68, 0, v68
    v_cvt_pk_bf16_f32 v69, 0, v69
    v_cvt_pk_bf16_f32 v70, 0, v70
    v_cvt_pk_bf16_f32 v71, 0, v71
    v_mul_f32 v72, s100, v68
    v_mul_f32 v73, s100, v69
    v_mul_f32 v74, s100, v70
    v_mul_f32 v75, s100, v71
    v_fract_f32 v72, v72
    v_fract_f32 v73, v73
    v_fract_f32 v74, v74
    v_fract_f32 v75, v75
    v_fma_f32 v68, v68, s101, v72
    v_fma_f32 v69, v69, s101, v73
    v_fma_f32 v70, v70, s101, v74
    v_fma_f32 v71, v71, s101, v75
    v_fract_f32 v68, v68
    v_fract_f32 v69, v69
    v_fract_f32 v70, v70
    v_fract_f32 v71, v71
    v_cos_f32 v68, v68
    v_cos_f32 v69, v69
    v_cos_f32 v70, v70
    v_cos_f32 v71, v71
    v_cvt_pk_bf16_f32 v24, v68, v69
    v_cvt_pk_bf16_f32 v25, v70, v71
    s_waitcnt lgkmcnt(11)
    v_and_b32 v12, 2, v8
    v_mad_i32_i24 v27, v12, -2, v8
    v_add_u32 v8, v8, v12
    ds_write_b16 v27, v24 offset:6212
    ds_write_b32 v8, v96 offset:6208
    s_waitcnt lgkmcnt(12)
    v_and_b32 v12, 2, v9
    v_mad_i32_i24 v13, v12, -2, v9
    v_add_u32 v9, v9, v12
    ds_write_b16_d16_hi v13, v24 offset:6212
    ds_write_b32 v9, v97 offset:6208
    s_waitcnt lgkmcnt(13)
    v_and_b32 v12, 2, v10
    v_mad_i32_i24 v27, v12, -2, v10
    v_add_u32 v10, v10, v12
    ds_write_b16 v27, v25 offset:6212
    ds_write_b32 v10, v98 offset:6208
    s_waitcnt lgkmcnt(14)
    v_and_b32 v12, 2, v11
    v_mad_i32_i24 v13, v12, -2, v11
    v_add_u32 v11, v11, v12
    ds_write_b16_d16_hi v13, v25 offset:6212
    ds_write_b32 v11, v99 offset:6208
    s_mov_b64 exec, s[36:37]
    s_waitcnt lgkmcnt(8)
    v_and_b32 v12, 2, v4
    v_mad_i32_i24 v27, v12, -2, v4
    v_add_u32 v4, v4, v12
    ds_write_b16_d16_hi v27, v127 offset:6212
    ds_write_b32 v4, v126 offset:6208
    s_mov_b64 exec, -1
    s_cmp_ge_u32 s2, 8
    s_cbranch_scc1 L_k1_nocp2
    s_getpc_b64 s[94:95]
    v_min_u32 v124, 160, v0
    v_lshlrev_b32 v124, 7, v124
    global_load_dword v124, v124, s[94:95]
L_k1_nocp2:
    s_add_u32 s45, s2, 256
    s_mul_i32 s46, s45, 157696
    s_add_u32 s46, s46, 4096
    s_add_u32 s16, s24, s46
    s_addc_u32 s17, s25, 0
    s_min_u32 s18, s47, 157696
    s_mul_i32 s46, s45, 3072
    s_add_u32 s46, s46, 80744448
    s_add_u32 s20, s24, s46
    s_addc_u32 s21, s25, 0
    v_mul_u32_u24 v4, 21846, v0
    v_lshrrev_b32 v4, 16, v4
    v_mad_i32_i24 v7, v4, -3, v0
    v_lshlrev_b32 v4, 2, v4
    v_lshl_add_u32 v4, v7, 11, v4
    v_mov_b32 v6, 0
    v_add_u32 v12, 49152, v1
    v_add_u32 v13, 98304, v1
    v_add_u32 v27, 147456, v1
    s_waitcnt lgkmcnt(0)
    s_barrier
    ds_read_b128 v[76:79], v1 offset:6208
    ds_read_b128 v[80:83], v1 offset:22592
    ds_read_b128 v[84:87], v1 offset:38976
    ds_read_b128 v[88:91], v12 offset:6208
    ds_read_b128 v[92:95], v12 offset:22592
    ds_read_b128 v[96:99], v12 offset:38976
    ds_read_b128 v[100:103], v13 offset:6208
    ds_read_b128 v[104:107], v13 offset:22592
    ds_read_b128 v[108:111], v13 offset:38976
    ds_read_b128 v[112:115], v27 offset:6208
    s_cmp_lt_u32 s38, 12
    s_cselect_b64 exec, -1, 0
    ds_wrxchg2st64_rtn_b32 v[8:9], v4, v6, v6 offset0:0 offset1:4
    s_mov_b64 exec, -1
    s_waitcnt lgkmcnt(9)
    s_mov_b32 s45, 0
    buffer_store_dwordx4 v[76:79], v1, s[16:19], s45 offen sc1
    s_waitcnt lgkmcnt(8)
    s_mov_b32 s45, 16384
    buffer_store_dwordx4 v[80:83], v1, s[16:19], s45 offen sc1
    s_waitcnt lgkmcnt(7)
    s_mov_b32 s45, 32768
    buffer_store_dwordx4 v[84:87], v1, s[16:19], s45 offen sc1
    s_waitcnt lgkmcnt(6)
    s_mov_b32 s45, 49152
    buffer_store_dwordx4 v[88:91], v1, s[16:19], s45 offen sc1
    s_waitcnt lgkmcnt(5)
    s_mov_b32 s45, 65536
    buffer_store_dwordx4 v[92:95], v1, s[16:19], s45 offen sc1
    s_waitcnt lgkmcnt(4)
    s_mov_b32 s45, 81920
    buffer_store_dwordx4 v[96:99], v1, s[16:19], s45 offen sc1
    s_waitcnt lgkmcnt(3)
    s_mov_b32 s45, 98304
    buffer_store_dwordx4 v[100:103], v1, s[16:19], s45 offen sc1
    s_waitcnt lgkmcnt(2)
    s_mov_b32 s45, 114688
    buffer_store_dwordx4 v[104:107], v1, s[16:19], s45 offen sc1
    s_waitcnt lgkmcnt(1)
    s_mov_b32 s45, 131072
    buffer_store_dwordx4 v[108:111], v1, s[16:19], s45 offen sc1
    s_waitcnt lgkmcnt(0)
    s_mov_b32 s45, 147456
    buffer_store_dwordx4 v[112:115], v1, s[16:19], s45 offen sc1
    s_waitcnt lgkmcnt(0)
    s_cmp_eq_u32 s92, 0
    s_cselect_b32 s45, 0, 0x10001
    v_mul_hi_u32 v8, v8, s40
    v_mul_hi_u32 v9, v9, s40
    v_lshlrev_b32 v4, 2, v0
    v_lshl_or_b32 v8, v9, 16, v8
    v_add_u32 v8, s45, v8
    v_bfi_b32 v8, s45, 0, v8
    buffer_store_dword v8, v4, s[20:23], 0 offen sc1
L_k1_end:
    s_endpgm
.globl gather_scatter__molecular_angular_gemnet__graph_kernel
.p2align 8
.type gather_scatter__molecular_angular_gemnet__graph_kernel,@function
gather_scatter__molecular_angular_gemnet__graph_kernel:
    s_cmp_ge_u32 s2, 256
    s_cbranch_scc1 L_k2_end
    s_load_dwordx2 s[8:9], s[0:1], 104
    s_load_dwordx2 s[16:17], s[0:1], 0
    s_load_dwordx2 s[20:21], s[0:1], 88
    s_load_dwordx2 s[24:25], s[0:1], 24
    s_load_dwordx2 s[92:93], s[0:1], 40
    s_load_dwordx2 s[94:95], s[0:1], 56
    s_load_dwordx4 s[96:99], s[0:1], 64
    s_load_dwordx2 s[100:101], s[0:1], 80
    v_lshrrev_b32 v1, 6, v0
    v_and_b32 v0, 63, v0
    v_readfirstlane_b32 s28, v1
    s_and_b32 s35, s2, 7
    s_lshr_b32 s31, s2, 3
    s_lshl_b32 s35, s35, 5
    s_add_u32 s29, s35, s31
    s_mov_b32 s14, 1572864
    s_mov_b32 s15, 0x20000
    s_mul_i32 s33, s29, 12
    s_sub_u32 s34, s33, 12
    s_cselect_b32 s34, 3060, s34
    v_mad_u32_u24 v88, v0, 14, s28
    v_mul_u32_u24 v80, 3072, v88
    s_waitcnt lgkmcnt(0)
    s_add_u32 s12, s8, 80744448
    s_addc_u32 s13, s9, 0
    s_setprio 3
    buffer_load_dwordx3 v[72:74], v80, s[12:15], s33 offen
    buffer_load_dwordx3 v[76:78], v80, s[12:15], s34 offen
    s_mov_b32 s10, 80744448
    s_mov_b32 s11, 0x20000
    s_mov_b32 s18, 25600000
    s_mov_b32 s19, 0x20000
    s_mov_b32 s22, 25600000
    s_mov_b32 s23, 0x20000
    s_mov_b32 s26, 1600000
    s_mov_b32 s27, 0x20000
    v_lshlrev_b32 v30, 4, v0
    s_movk_i32 s40, 0xf0
    s_mul_i32 s38, s28, 2048
    s_lshl_b32 s35, s28, 11
    s_add_u32 s38, s38, 103424
    s_mov_b32 s41, 0
    s_lshl_b32 s36, s28, 9
    s_add_u32 s42, s36, 54848
    s_add_u32 s35, s35, 74752
    v_mov_b32 v14, 0
    v_mov_b32 v15, 0
    v_mov_b32 v16, 0
    v_mov_b32 v17, 0
    v_mov_b32 v18, 0
    v_mov_b32 v19, 0
    v_mov_b32 v20, 0
    v_mov_b32 v21, 0
    v_add_u32 v2, s35, v30
    v_add_u32 v31, s38, v30
    v_lshl_add_u32 v89, v0, 3, s42
    ds_write_b64 v89, v[14:15]
    ds_write_b128 v2, v[14:17]
    ds_write_b128 v2, v[14:17] offset:1024
    ds_write_b128 v14, v[14:17] offset:52768
    v_and_b32 v32, 1, v0
    v_lshrrev_b32 v33, 1, v0
    s_lshl_b32 s36, s28, 3
    v_lshl_add_u32 v51, v32, 2, s36
    s_movk_i32 s36, 112
    v_mad_u32_u24 v59, v33, s36, v51
    s_mul_i32 s36, s28, 528
    v_lshl_add_u32 v47, v0, 3, s36
    v_lshl_add_u32 v63, v32, 3, s36
    s_movk_i32 s36, 7392
    v_mad_u32_u24 v63, v33, s36, v63
    s_mov_b64 exec, 0x3fff
    ds_write_b32 v59, v63 offset:51744
    s_mov_b64 exec, -1
    v_add_u32 v33, 1, v33
    v_lshlrev_b32 v5, 16, v33
    v_mov_b32 v55, 0x10010
    v_lshlrev_b32 v6, 4, v32
    v_or_b32 v6, 33554400, v6
    v_lshrrev_b32 v31, 4, v0
    v_lshrrev_b32 v30, 3, v0
    v_xor_b32 v30, v30, v31
    v_and_b32 v30, 1, v30
    v_and_b32 v33, 6, v0
    v_lshl_add_u32 v33, v30, 3, v33
    v_lshl_add_u32 v33, v31, 8, v33
    v_lshl_add_u32 v33, v32, 10, v33
    v_add_u32 v1, s35, v33
    v_and_b32 v32, 15, v0
    v_lshlrev_b32 v32, 3, v32
    v_lshl_add_u32 v32, v31, 8, v32
    v_and_b32 v31, 1, v31
    v_lshl_add_u32 v32, v31, 7, v32
    v_add_u32 v3, s38, v32
    v_xor_b32 v4, 0x80, v3
    v_mul_u32_u24 v88, 157696, v88
    v_add_u32 v88, 4096, v88
    s_mov_b32 s30, 1
    s_mov_b32 s3, 1
    s_mov_b32 s32, 0
    s_and_b32 s36, s29, 16
    s_cselect_b32 s30, 2, 1
    s_mov_b32 s88, 74800
    s_lshr_b32 s4, s29, 5
    s_lshl_b32 s4, s4, 29
    s_movk_i32 s5, -5368
    s_mov_b32 s6, 0
    s_movk_i32 s7, 0
    v_mov_b32 v11, s4
    s_waitcnt lgkmcnt(0)
    s_barrier
    s_and_b32 s36, s29, 31
    s_mul_i32 s36, s36, 14
    s_add_u32 s36, s36, s28
    s_mul_i32 s36, s36, 1024
    s_add_u32 s36, s36, 0
    v_min_u32 v11, 7, v0
    v_lshl_add_u32 v11, v11, 7, s36
    buffer_load_dword v68, v11, s[16:19], 0 offen
    s_waitcnt vmcnt(1)
    s_cmp_lg_u32 s29, 0
    s_cbranch_scc1 L_k2_bnz
    v_alignbit_b32 v78, v78, v77, 16
    v_alignbit_b32 v77, v77, v76, 16
    v_lshlrev_b32 v76, 16, v76
L_k2_bnz:
    v_sub_u32 v80, v72, v76
    v_sub_u32 v81, v73, v77
    v_sub_u32 v82, v74, v78
    v_or3_b32 v30, v80, v81, v82
    v_or3_b32 v31, v76, v77, v78
    v_lshrrev_b32 v80, 1, v80
    v_lshrrev_b32 v81, 1, v81
    v_lshrrev_b32 v82, 1, v82
    v_and_b32 v31, 0x10001, v31
    v_mov_b32 v84, v80
    v_mov_b32 v85, v81
    v_mov_b32 v86, v82
    v_or_b32 v30, v30, v31
    v_and_b32 v30, 0xfe01fe01, v30
    v_cmp_ne_u32 vcc, 0, v30
    v_add_u32_dpp v84, v84, v84 row_shr:1 row_mask:0xf bank_mask:0xf
    v_add_u32_dpp v85, v85, v85 row_shr:1 row_mask:0xf bank_mask:0xf
    v_add_u32_dpp v86, v86, v86 row_shr:1 row_mask:0xf bank_mask:0xf
    v_add_u32_dpp v84, v84, v84 row_shr:2 row_mask:0xf bank_mask:0xf
    v_add_u32_dpp v85, v85, v85 row_shr:2 row_mask:0xf bank_mask:0xf
    v_add_u32_dpp v86, v86, v86 row_shr:2 row_mask:0xf bank_mask:0xf
    v_add_u32_dpp v84, v84, v84 row_shr:4 row_mask:0xf bank_mask:0xf
    v_add_u32_dpp v85, v85, v85 row_shr:4 row_mask:0xf bank_mask:0xf
    v_add_u32_dpp v86, v86, v86 row_shr:4 row_mask:0xf bank_mask:0xf
    v_add_u32_dpp v84, v84, v84 row_shr:8 row_mask:0xf bank_mask:0xf
    v_add_u32_dpp v85, v85, v85 row_shr:8 row_mask:0xf bank_mask:0xf
    v_add_u32_dpp v86, v86, v86 row_shr:8 row_mask:0xf bank_mask:0xf
    v_add_u32_dpp v84, v84, v84 row_bcast:15 row_mask:0xa bank_mask:0xf
    v_add_u32_dpp v85, v85, v85 row_bcast:15 row_mask:0xa bank_mask:0xf
    v_add_u32_dpp v86, v86, v86 row_bcast:15 row_mask:0xa bank_mask:0xf
    v_add_u32_dpp v84, v84, v84 row_bcast:31 row_mask:0xc bank_mask:0xf
    v_add_u32_dpp v85, v85, v85 row_bcast:31 row_mask:0xc bank_mask:0xf
    v_add_u32_dpp v86, v86, v86 row_bcast:31 row_mask:0xc bank_mask:0xf
    v_readlane_b32 s83, v84, 63
    v_readlane_b32 s85, v85, 63
    v_readlane_b32 s87, v86, 63
    v_sub_u32 v84, v84, v80
    v_lshrrev_b32 v76, 1, v76
    v_sub_u32 v85, v85, v81
    v_lshrrev_b32 v77, 1, v77
    v_sub_u32 v86, v86, v82
    v_lshrrev_b32 v78, 1, v78
    s_and_b32 s82, s83, 0xffff
    s_lshr_b32 s83, s83, 16
    s_add_u32 s83, s83, s82
    s_and_b32 s84, s85, 0xffff
    s_lshr_b32 s85, s85, 16
    s_add_u32 s84, s84, s83
    s_add_u32 s85, s85, s84
    s_and_b32 s86, s87, 0xffff
    s_lshr_b32 s87, s87, 16
    s_add_u32 s86, s86, s85
    s_add_u32 s87, s87, s86
    s_mov_b32 s33, s87
    s_cbranch_vccnz L_k2_setslow
    s_cmp_le_u32 s33, 2048
    s_cbranch_scc1 L_k2_tabok
L_k2_setslow:
    v_mov_b32 v30, 0
    v_mov_b32 v31, 1
    ds_write_b32 v30, v31 offset:52772
    s_branch L_k2_first
L_k2_tabok:
    s_mul_i32 s70, s28, 896
    s_add_u32 s70, s70, 62016
    s_lshr_b32 s71, s70, 2
    s_sub_u32 s71, s71, 1
    v_cmp_ne_u32_sdwa vcc, v80, 0 src0_sel:WORD_0 src1_sel:DWORD
    v_add_u32_sdwa v23, 0, v84 dst_sel:DWORD dst_unused:UNUSED_PAD src0_sel:DWORD src1_sel:WORD_0
    s_bcnt1_i32_b64 s36, vcc
    v_sub_u32_sdwa v22, v76, v23 dst_sel:DWORD dst_unused:UNUSED_PAD src0_sel:WORD_0 src1_sel:DWORD
    v_mbcnt_lo_u32_b32 v24, vcc_lo, 0
    v_mad_i32_i24 v22, v22, 12, v88
    v_mbcnt_hi_u32_b32 v24, vcc_hi, v24
    v_lshlrev_b32 v25, v23, 1
    v_lshl_add_u32 v24, v24, 2, s70
    v_lshrrev_b32 v23, 5, v23
    v_lshl_add_u32 v23, v23, 3, s42
    s_mov_b64 exec, vcc
    ds_write_b32 v24, v22
    ds_or_b32 v23, v25
    s_mov_b64 exec, -1
    s_lshl2_add_u32 s70, s36, s70
    v_cmp_ne_u32_sdwa vcc, v80, 0 src0_sel:WORD_1 src1_sel:DWORD
    v_add_u32_sdwa v27, s82, v84 dst_sel:DWORD dst_unused:UNUSED_PAD src0_sel:DWORD src1_sel:WORD_1
    s_bcnt1_i32_b64 s36, vcc
    v_sub_u32_sdwa v26, v76, v27 dst_sel:DWORD dst_unused:UNUSED_PAD src0_sel:WORD_1 src1_sel:DWORD
    v_mbcnt_lo_u32_b32 v28, vcc_lo, 0
    v_mad_i32_i24 v26, v26, 12, v88
    v_mbcnt_hi_u32_b32 v28, vcc_hi, v28
    v_lshlrev_b32 v29, v27, 1
    v_lshl_add_u32 v28, v28, 2, s70
    v_lshrrev_b32 v27, 5, v27
    v_lshl_add_u32 v27, v27, 3, s42
    s_mov_b64 exec, vcc
    ds_write_b32 v28, v26
    ds_or_b32 v27, v29
    s_mov_b64 exec, -1
    s_lshl2_add_u32 s70, s36, s70
    v_cmp_ne_u32_sdwa vcc, v81, 0 src0_sel:WORD_0 src1_sel:DWORD
    v_add_u32_sdwa v23, s83, v85 dst_sel:DWORD dst_unused:UNUSED_PAD src0_sel:DWORD src1_sel:WORD_0
    s_bcnt1_i32_b64 s36, vcc
    v_sub_u32_sdwa v22, v77, v23 dst_sel:DWORD dst_unused:UNUSED_PAD src0_sel:WORD_0 src1_sel:DWORD
    v_mbcnt_lo_u32_b32 v24, vcc_lo, 0
    v_mad_i32_i24 v22, v22, 12, v88
    v_mbcnt_hi_u32_b32 v24, vcc_hi, v24
    v_lshlrev_b32 v25, v23, 1
    v_lshl_add_u32 v24, v24, 2, s70
    v_lshrrev_b32 v23, 5, v23
    v_lshl_add_u32 v23, v23, 3, s42
    s_mov_b64 exec, vcc
    ds_write_b32 v24, v22
    ds_or_b32 v23, v25
    s_mov_b64 exec, -1
    s_lshl2_add_u32 s70, s36, s70
    v_cmp_ne_u32_sdwa vcc, v81, 0 src0_sel:WORD_1 src1_sel:DWORD
    v_add_u32_sdwa v27, s84, v85 dst_sel:DWORD dst_unused:UNUSED_PAD src0_sel:DWORD src1_sel:WORD_1
    s_bcnt1_i32_b64 s36, vcc
    v_sub_u32_sdwa v26, v77, v27 dst_sel:DWORD dst_unused:UNUSED_PAD src0_sel:WORD_1 src1_sel:DWORD
    v_mbcnt_lo_u32_b32 v28, vcc_lo, 0
    v_mad_i32_i24 v26, v26, 12, v88
    v_mbcnt_hi_u32_b32 v28, vcc_hi, v28
    v_lshlrev_b32 v29, v27, 1
    v_lshl_add_u32 v28, v28, 2, s70
    v_lshrrev_b32 v27, 5, v27
    v_lshl_add_u32 v27, v27, 3, s42
    s_mov_b64 exec, vcc
    ds_write_b32 v28, v26
    ds_or_b32 v27, v29
    s_mov_b64 exec, -1
    s_lshl2_add_u32 s70, s36, s70
    v_cmp_ne_u32_sdwa vcc, v82, 0 src0_sel:WORD_0 src1_sel:DWORD
    v_add_u32_sdwa v23, s85, v86 dst_sel:DWORD dst_unused:UNUSED_PAD src0_sel:DWORD src1_sel:WORD_0
    s_bcnt1_i32_b64 s36, vcc
    v_sub_u32_sdwa v22, v78, v23 dst_sel:DWORD dst_unused:UNUSED_PAD src0_sel:WORD_0 src1_sel:DWORD
    v_mbcnt_lo_u32_b32 v24, vcc_lo, 0
    v_mad_i32_i24 v22, v22, 12, v88
    v_mbcnt_hi_u32_b32 v24, vcc_hi, v24
    v_lshlrev_b32 v25, v23, 1
    v_lshl_add_u32 v24, v24, 2, s70
    v_lshrrev_b32 v23, 5, v23
    v_lshl_add_u32 v23, v23, 3, s42
    s_mov_b64 exec, vcc
    ds_write_b32 v24, v22
    ds_or_b32 v23, v25
    s_mov_b64 exec, -1
    s_lshl2_add_u32 s70, s36, s70
    v_cmp_ne_u32_sdwa vcc, v82, 0 src0_sel:WORD_1 src1_sel:DWORD
    v_add_u32_sdwa v27, s86, v86 dst_sel:DWORD dst_unused:UNUSED_PAD src0_sel:DWORD src1_sel:WORD_1
    s_bcnt1_i32_b64 s36, vcc
    v_sub_u32_sdwa v26, v78, v27 dst_sel:DWORD dst_unused:UNUSED_PAD src0_sel:WORD_1 src1_sel:DWORD
    v_mbcnt_lo_u32_b32 v28, vcc_lo, 0
    v_mad_i32_i24 v26, v26, 12, v88
    v_mbcnt_hi_u32_b32 v28, vcc_hi, v28
    v_lshlrev_b32 v29, v27, 1
    v_lshl_add_u32 v28, v28, 2, s70
    v_lshrrev_b32 v27, 5, v27
    v_lshl_add_u32 v27, v27, 3, s42
    s_mov_b64 exec, vcc
    ds_write_b32 v28, v26
    ds_or_b32 v27, v29
    s_mov_b64 exec, -1
    s_lshl2_add_u32 s70, s36, s70
    ds_read_b32 v67, v89
    s_waitcnt lgkmcnt(0)
    v_bcnt_u32_b32 v67, v67, 0
    v_mov_b32 v71, v67
    s_nop 1
    v_add_u32_dpp v71, v71, v71 row_shr:1 row_mask:0xf bank_mask:0xf
    s_nop 1
    v_add_u32_dpp v71, v71, v71 row_shr:2 row_mask:0xf bank_mask:0xf
    s_nop 1
    v_add_u32_dpp v71, v71, v71 row_shr:4 row_mask:0xf bank_mask:0xf
    s_nop 1
    v_add_u32_dpp v71, v71, v71 row_shr:8 row_mask:0xf bank_mask:0xf
    s_nop 1
    v_add_u32_dpp v71, v71, v71 row_bcast:15 row_mask:0xa bank_mask:0xf
    s_nop 1
    v_add_u32_dpp v71, v71, v71 row_bcast:31 row_mask:0xc bank_mask:0xf
    v_sub_u32 v71, v71, v67
    v_add_u32 v71, s71, v71
    ds_write_b32 v89, v71 offset:4
    s_setprio 3
    s_mov_b32 s31, s32
    s_add_u32 s32, s31, 384
    s_min_u32 s32, s32, s82
    s_mov_b32 s82, s83
    s_mov_b32 s83, s84
    s_mov_b32 s84, s85
    s_mov_b32 s85, s86
    s_mov_b32 s86, s87
    s_cmp_eq_u32 s30, 2
    s_cselect_b32 s88, -1, s88
    s_add_u32 s36, s31, 0
    v_add_u32 v22, s36, v0
    v_lshrrev_b32 v23, 5, v22
    v_lshl_add_u32 v23, v23, 3, s42
    ds_read_b64 v[44:45], v23 offset:0
    ds_read_b64 v[48:49], v23 offset:16
    ds_read_b64 v[52:53], v23 offset:32
    ds_read_b64 v[56:57], v23 offset:48
    v_not_b32 v24, v22
    v_mul_u32_u24 v25, 12, v22
    s_sub_i32 s35, s32, 0
    v_cmp_gt_i32 s[46:47], s35, v22
    s_waitcnt lgkmcnt(3)
    v_lshlrev_b32 v44, v24, v44
    v_bcnt_u32_b32 v44, v44, v45
    v_lshlrev_b32 v44, 2, v44
    ds_read_b32 v44, v44
    s_sub_i32 s35, s32, 64
    v_cmp_gt_i32 s[50:51], s35, v22
    s_waitcnt lgkmcnt(3)
    v_lshlrev_b32 v48, v24, v48
    v_bcnt_u32_b32 v48, v48, v49
    v_lshlrev_b32 v48, 2, v48
    ds_read_b32 v48, v48
    s_sub_i32 s35, s32, 128
    v_cmp_gt_i32 s[54:55], s35, v22
    s_waitcnt lgkmcnt(3)
    v_lshlrev_b32 v52, v24, v52
    v_bcnt_u32_b32 v52, v52, v53
    v_lshlrev_b32 v52, 2, v52
    ds_read_b32 v52, v52
    s_sub_i32 s35, s32, 192
    v_cmp_gt_i32 s[58:59], s35, v22
    s_waitcnt lgkmcnt(3)
    v_lshlrev_b32 v56, v24, v56
    v_bcnt_u32_b32 v56, v56, v57
    v_lshlrev_b32 v56, 2, v56
    ds_read_b32 v56, v56
    s_waitcnt lgkmcnt(3)
    v_add_u32 v44, v44, v25
    v_cndmask_b32 v44, -16, v44, s[46:47]
    buffer_load_dwordx3 v[44:46], v44, s[8:11], 0 offen offset:0
    s_waitcnt lgkmcnt(2)
    v_add_u32 v48, v48, v25
    v_cndmask_b32 v48, -16, v48, s[50:51]
    buffer_load_dwordx3 v[48:50], v48, s[8:11], 0 offen offset:768
    s_waitcnt lgkmcnt(1)
    v_add_u32 v52, v52, v25
    v_cndmask_b32 v52, -16, v52, s[54:55]
    buffer_load_dwordx3 v[52:54], v52, s[8:11], 0 offen offset:1536
    s_waitcnt lgkmcnt(0)
    v_add_u32 v56, v56, v25
    v_cndmask_b32 v56, -16, v56, s[58:59]
    buffer_load_dwordx3 v[56:58], v56, s[8:11], 0 offen offset:2304
    s_add_u32 s36, s31, 256
    v_add_u32 v22, s36, v0
    v_lshrrev_b32 v23, 5, v22
    v_lshl_add_u32 v23, v23, 3, s42
    ds_read_b64 v[60:61], v23 offset:0
    ds_read_b64 v[64:65], v23 offset:16
    v_not_b32 v24, v22
    v_mul_u32_u24 v25, 12, v22
    s_sub_i32 s35, s32, 0
    v_cmp_gt_i32 s[62:63], s35, v22
    s_waitcnt lgkmcnt(1)
    v_lshlrev_b32 v60, v24, v60
    v_bcnt_u32_b32 v60, v60, v61
    v_lshlrev_b32 v60, 2, v60
    ds_read_b32 v60, v60
    s_sub_i32 s35, s32, 64
    v_cmp_gt_i32 s[66:67], s35, v22
    s_waitcnt lgkmcnt(1)
    v_lshlrev_b32 v64, v24, v64
    v_bcnt_u32_b32 v64, v64, v65
    v_lshlrev_b32 v64, 2, v64
    ds_read_b32 v64, v64
    s_waitcnt lgkmcnt(1)
    v_add_u32 v60, v60, v25
    v_cndmask_b32 v60, -16, v60, s[62:63]
    buffer_load_dwordx3 v[60:62], v60, s[8:11], 0 offen offset:0
    s_waitcnt lgkmcnt(0)
    v_add_u32 v64, v64, v25
    v_cndmask_b32 v64, -16, v64, s[66:67]
    buffer_load_dwordx3 v[64:66], v64, s[8:11], 0 offen offset:768
    s_setprio 2
    v_mov_b32 v72, 0
    v_mov_b32 v73, 0
    v_mov_b32 v74, 0
    v_mov_b32 v75, 0
    v_mov_b32 v76, 0
    v_mov_b32 v77, 0
    v_mov_b32 v78, 0
    v_mov_b32 v79, 0
    v_mov_b32 v80, 0
    v_mov_b32 v81, 0
    v_mov_b32 v82, 0
    v_mov_b32 v83, 0
    v_mov_b32 v84, 0
    v_mov_b32 v85, 0
    v_mov_b32 v86, 0
    v_mov_b32 v87, 0
    v_mov_b32 v88, 0
    v_mov_b32 v89, 0
    v_mov_b32 v90, 0
    v_mov_b32 v91, 0
    v_mov_b32 v92, 0
    v_mov_b32 v93, 0
    v_mov_b32 v94, 0
    v_mov_b32 v95, 0
    v_mov_b32 v96, 0
    v_mov_b32 v97, 0
    v_mov_b32 v98, 0
    v_mov_b32 v99, 0
    v_mov_b32 v100, 0
    v_mov_b32 v101, 0
    v_mov_b32 v102, 0
    v_mov_b32 v103, 0
    v_mov_b32 v104, 0
    v_mov_b32 v105, 0
    v_mov_b32 v106, 0
    v_mov_b32 v107, 0
    v_mov_b32 v108, 0
    v_mov_b32 v109, 0
    v_mov_b32 v110, 0
    v_mov_b32 v111, 0
    v_mov_b32 v112, 0
    v_mov_b32 v113, 0
    v_mov_b32 v114, 0
    v_mov_b32 v115, 0
    v_mov_b32 v116, 0
    v_mov_b32 v117, 0
    v_mov_b32 v118, 0
    v_mov_b32 v119, 0
    v_mov_b32 v120, 0
    v_mov_b32 v121, 0
    v_mov_b32 v122, 0
    v_mov_b32 v123, 0
    v_mov_b32 v124, 0
    v_mov_b32 v125, 0
    v_mov_b32 v126, 0
    v_mov_b32 v127, 0
    s_cmp_ge_u32 s31, s33
    s_cbranch_scc1 L_fl_1
    v_mov_b32 v67, 0
    v_mov_b32 v71, s30
    ds_write_b32 v67, v71 offset:52768
L_fl_1:
    s_waitcnt vmcnt(4)
    s_setprio 2
    s_mov_b64 s[48:49], s[46:47]
    s_mov_b64 s[52:53], s[50:51]
    s_cmp_eq_u64 s[46:47], 0
    s_cbranch_scc1 L_sc_2
    v_and_b32 v67, 0xfffff, v44
    v_and_b32 v71, 0xfffff, v46
    v_cmp_ne_u32 vcc, -1, v46
    v_cmp_gt_u32 s[74:75], s88, v67
    v_cmp_gt_u32 s[76:77], s88, v71
    s_and_b64 s[48:49], s[46:47], vcc
    s_and_b64 s[74:75], s[74:75], s[46:47]
    s_and_b64 s[76:77], s[76:77], s[48:49]
    s_andn2_b64 s[46:47], s[46:47], s[74:75]
    s_andn2_b64 s[48:49], s[48:49], s[76:77]
    v_and_b32 v67, 0xfffff, v48
    v_and_b32 v71, 0xfffff, v50
    v_cmp_ne_u32 vcc, -1, v50
    v_cmp_gt_u32 s[78:79], s88, v67
    v_cmp_gt_u32 s[80:81], s88, v71
    s_and_b64 s[52:53], s[50:51], vcc
    s_and_b64 s[78:79], s[78:79], s[50:51]
    s_and_b64 s[80:81], s[80:81], s[52:53]
    s_andn2_b64 s[50:51], s[50:51], s[78:79]
    s_andn2_b64 s[52:53], s[52:53], s[80:81]
    s_mov_b64 exec, s[74:75]
    v_lshlrev_b32_sdwa v24, 2, v44 dst_sel:DWORD dst_unused:UNUSED_PAD src0_sel:DWORD src1_sel:BYTE_3
    ds_add_rtn_u32 v24, v24, v55 offset:51744
    s_mov_b64 exec, s[76:77]
    v_lshlrev_b32_sdwa v25, 2, v46 dst_sel:DWORD dst_unused:UNUSED_PAD src0_sel:DWORD src1_sel:BYTE_3
    ds_add_rtn_u32 v25, v25, v55 offset:51744
    v_mov_b32 v22, v46
    v_lshrrev_b32 v23, 16, v45
    s_mov_b64 exec, s[78:79]
    v_lshlrev_b32_sdwa v28, 2, v48 dst_sel:DWORD dst_unused:UNUSED_PAD src0_sel:DWORD src1_sel:BYTE_3
    ds_add_rtn_u32 v28, v28, v55 offset:51744
    s_mov_b64 exec, s[80:81]
    v_lshlrev_b32_sdwa v29, 2, v50 dst_sel:DWORD dst_unused:UNUSED_PAD src0_sel:DWORD src1_sel:BYTE_3
    ds_add_rtn_u32 v29, v29, v55 offset:51744
    v_mov_b32 v26, v50
    v_lshrrev_b32 v27, 16, v49
    s_mov_b64 exec, s[74:75]
    s_waitcnt lgkmcnt(0)
    v_cmp_gt_u32 vcc, 0x200000, v24
    v_and_b32 v24, 0xffff, v24
    s_andn2_b64 s[44:45], exec, vcc
    s_mov_b64 exec, vcc
    ds_write_b64 v24, v[44:45]
    s_cbranch_scc0 L_pl_3
    s_mov_b64 exec, s[44:45]
    v_mov_b32 v67, 0
    v_mov_b32 v71, 8
    ds_add_rtn_u32 v67, v67, v71 offset:52776
    s_waitcnt lgkmcnt(0)
    v_and_b32 v67, 2047, v67
    ds_write_b64 v67, v[44:45] offset:52800
L_pl_3:
    s_mov_b64 exec, s[76:77]
    v_cmp_gt_u32 vcc, 0x200000, v25
    v_and_b32 v25, 0xffff, v25
    s_andn2_b64 s[44:45], exec, vcc
    s_mov_b64 exec, vcc
    ds_write_b64 v25, v[22:23]
    s_cbranch_scc0 L_pl_5
    s_mov_b64 exec, s[44:45]
    v_mov_b32 v67, 0
    v_mov_b32 v71, 8
    ds_add_rtn_u32 v67, v67, v71 offset:52776
    s_waitcnt lgkmcnt(0)
    v_and_b32 v67, 2047, v67
    ds_write_b64 v67, v[22:23] offset:52800
L_pl_5:
    s_mov_b64 exec, s[78:79]
    v_cmp_gt_u32 vcc, 0x200000, v28
    v_and_b32 v28, 0xffff, v28
    s_andn2_b64 s[44:45], exec, vcc
    s_mov_b64 exec, vcc
    ds_write_b64 v28, v[48:49]
    s_cbranch_scc0 L_pl_7
    s_mov_b64 exec, s[44:45]
    v_mov_b32 v67, 0
    v_mov_b32 v71, 8
    ds_add_rtn_u32 v67, v67, v71 offset:52776
    s_waitcnt lgkmcnt(0)
    v_and_b32 v67, 2047, v67
    ds_write_b64 v67, v[48:49] offset:52800
L_pl_7:
    s_mov_b64 exec, s[80:81]
    v_cmp_gt_u32 vcc, 0x200000, v29
    v_and_b32 v29, 0xffff, v29
    s_andn2_b64 s[44:45], exec, vcc
    s_mov_b64 exec, vcc
    ds_write_b64 v29, v[26:27]
    s_cbranch_scc0 L_pl_9
    s_mov_b64 exec, s[44:45]
    v_mov_b32 v67, 0
    v_mov_b32 v71, 8
    ds_add_rtn_u32 v67, v67, v71 offset:52776
    s_waitcnt lgkmcnt(0)
    v_and_b32 v67, 2047, v67
    ds_write_b64 v67, v[26:27] offset:52800
L_pl_9:
    s_mov_b64 exec, -1
L_sc_2:
    s_waitcnt vmcnt(2)
    s_setprio 1
    s_mov_b64 s[56:57], s[54:55]
    s_mov_b64 s[60:61], s[58:59]
    s_cmp_eq_u64 s[54:55], 0
    s_cbranch_scc1 L_sc_11
    v_and_b32 v67, 0xfffff, v52
    v_and_b32 v71, 0xfffff, v54
    v_cmp_ne_u32 vcc, -1, v54
    v_cmp_gt_u32 s[74:75], s88, v67
    v_cmp_gt_u32 s[76:77], s88, v71
    s_and_b64 s[56:57], s[54:55], vcc
    s_and_b64 s[74:75], s[74:75], s[54:55]
    s_and_b64 s[76:77], s[76:77], s[56:57]
    s_andn2_b64 s[54:55], s[54:55], s[74:75]
    s_andn2_b64 s[56:57], s[56:57], s[76:77]
    v_and_b32 v67, 0xfffff, v56
    v_and_b32 v71, 0xfffff, v58
    v_cmp_ne_u32 vcc, -1, v58
    v_cmp_gt_u32 s[78:79], s88, v67
    v_cmp_gt_u32 s[80:81], s88, v71
    s_and_b64 s[60:61], s[58:59], vcc
    s_and_b64 s[78:79], s[78:79], s[58:59]
    s_and_b64 s[80:81], s[80:81], s[60:61]
    s_andn2_b64 s[58:59], s[58:59], s[78:79]
    s_andn2_b64 s[60:61], s[60:61], s[80:81]
    s_mov_b64 exec, s[74:75]
    v_lshlrev_b32_sdwa v24, 2, v52 dst_sel:DWORD dst_unused:UNUSED_PAD src0_sel:DWORD src1_sel:BYTE_3
    ds_add_rtn_u32 v24, v24, v55 offset:51744
    s_mov_b64 exec, s[76:77]
    v_lshlrev_b32_sdwa v25, 2, v54 dst_sel:DWORD dst_unused:UNUSED_PAD src0_sel:DWORD src1_sel:BYTE_3
    ds_add_rtn_u32 v25, v25, v55 offset:51744
    v_mov_b32 v22, v54
    v_lshrrev_b32 v23, 16, v53
    s_mov_b64 exec, s[78:79]
    v_lshlrev_b32_sdwa v28, 2, v56 dst_sel:DWORD dst_unused:UNUSED_PAD src0_sel:DWORD src1_sel:BYTE_3
    ds_add_rtn_u32 v28, v28, v55 offset:51744
    s_mov_b64 exec, s[80:81]
    v_lshlrev_b32_sdwa v29, 2, v58 dst_sel:DWORD dst_unused:UNUSED_PAD src0_sel:DWORD src1_sel:BYTE_3
    ds_add_rtn_u32 v29, v29, v55 offset:51744
    v_mov_b32 v26, v58
    v_lshrrev_b32 v27, 16, v57
    s_mov_b64 exec, s[74:75]
    s_waitcnt lgkmcnt(0)
    v_cmp_gt_u32 vcc, 0x200000, v24
    v_and_b32 v24, 0xffff, v24
    s_andn2_b64 s[44:45], exec, vcc
    s_mov_b64 exec, vcc
    ds_write_b64 v24, v[52:53]
    s_cbranch_scc0 L_pl_12
    s_mov_b64 exec, s[44:45]
    v_mov_b32 v67, 0
    v_mov_b32 v71, 8
    ds_add_rtn_u32 v67, v67, v71 offset:52776
    s_waitcnt lgkmcnt(0)
    v_and_b32 v67, 2047, v67
    ds_write_b64 v67, v[52:53] offset:52800
L_pl_12:
    s_mov_b64 exec, s[76:77]
    v_cmp_gt_u32 vcc, 0x200000, v25
    v_and_b32 v25, 0xffff, v25
    s_andn2_b64 s[44:45], exec, vcc
    s_mov_b64 exec, vcc
    ds_write_b64 v25, v[22:23]
    s_cbranch_scc0 L_pl_14
    s_mov_b64 exec, s[44:45]
    v_mov_b32 v67, 0
    v_mov_b32 v71, 8
    ds_add_rtn_u32 v67, v67, v71 offset:52776
    s_waitcnt lgkmcnt(0)
    v_and_b32 v67, 2047, v67
    ds_write_b64 v67, v[22:23] offset:52800
L_pl_14:
    s_mov_b64 exec, s[78:79]
    v_cmp_gt_u32 vcc, 0x200000, v28
    v_and_b32 v28, 0xffff, v28
    s_andn2_b64 s[44:45], exec, vcc
    s_mov_b64 exec, vcc
    ds_write_b64 v28, v[56:57]
    s_cbranch_scc0 L_pl_16
    s_mov_b64 exec, s[44:45]
    v_mov_b32 v67, 0
    v_mov_b32 v71, 8
    ds_add_rtn_u32 v67, v67, v71 offset:52776
    s_waitcnt lgkmcnt(0)
    v_and_b32 v67, 2047, v67
    ds_write_b64 v67, v[56:57] offset:52800
L_pl_16:
    s_mov_b64 exec, s[80:81]
    v_cmp_gt_u32 vcc, 0x200000, v29
    v_and_b32 v29, 0xffff, v29
    s_andn2_b64 s[44:45], exec, vcc
    s_mov_b64 exec, vcc
    ds_write_b64 v29, v[26:27]
    s_cbranch_scc0 L_pl_18
    s_mov_b64 exec, s[44:45]
    v_mov_b32 v67, 0
    v_mov_b32 v71, 8
    ds_add_rtn_u32 v67, v67, v71 offset:52776
    s_waitcnt lgkmcnt(0)
    v_and_b32 v67, 2047, v67
    ds_write_b64 v67, v[26:27] offset:52800
L_pl_18:
    s_mov_b64 exec, -1
L_sc_11:
    s_waitcnt vmcnt(0)
    s_setprio 0
    s_mov_b64 s[64:65], s[62:63]
    s_mov_b64 s[68:69], s[66:67]
    s_cmp_eq_u64 s[62:63], 0
    s_cbranch_scc1 L_sc_20
    v_and_b32 v67, 0xfffff, v60
    v_and_b32 v71, 0xfffff, v62
    v_cmp_ne_u32 vcc, -1, v62
    v_cmp_gt_u32 s[74:75], s88, v67
    v_cmp_gt_u32 s[76:77], s88, v71
    s_and_b64 s[64:65], s[62:63], vcc
    s_and_b64 s[74:75], s[74:75], s[62:63]
    s_and_b64 s[76:77], s[76:77], s[64:65]
    s_andn2_b64 s[62:63], s[62:63], s[74:75]
    s_andn2_b64 s[64:65], s[64:65], s[76:77]
    v_and_b32 v67, 0xfffff, v64
    v_and_b32 v71, 0xfffff, v66
    v_cmp_ne_u32 vcc, -1, v66
    v_cmp_gt_u32 s[78:79], s88, v67
    v_cmp_gt_u32 s[80:81], s88, v71
    s_and_b64 s[68:69], s[66:67], vcc
    s_and_b64 s[78:79], s[78:79], s[66:67]
    s_and_b64 s[80:81], s[80:81], s[68:69]
    s_andn2_b64 s[66:67], s[66:67], s[78:79]
    s_andn2_b64 s[68:69], s[68:69], s[80:81]
    s_mov_b64 exec, s[74:75]
    v_lshlrev_b32_sdwa v24, 2, v60 dst_sel:DWORD dst_unused:UNUSED_PAD src0_sel:DWORD src1_sel:BYTE_3
    ds_add_rtn_u32 v24, v24, v55 offset:51744
    s_mov_b64 exec, s[76:77]
    v_lshlrev_b32_sdwa v25, 2, v62 dst_sel:DWORD dst_unused:UNUSED_PAD src0_sel:DWORD src1_sel:BYTE_3
    ds_add_rtn_u32 v25, v25, v55 offset:51744
    v_mov_b32 v22, v62
    v_lshrrev_b32 v23, 16, v61
    s_mov_b64 exec, s[78:79]
    v_lshlrev_b32_sdwa v28, 2, v64 dst_sel:DWORD dst_unused:UNUSED_PAD src0_sel:DWORD src1_sel:BYTE_3
    ds_add_rtn_u32 v28, v28, v55 offset:51744
    s_mov_b64 exec, s[80:81]
    v_lshlrev_b32_sdwa v29, 2, v66 dst_sel:DWORD dst_unused:UNUSED_PAD src0_sel:DWORD src1_sel:BYTE_3
    ds_add_rtn_u32 v29, v29, v55 offset:51744
    v_mov_b32 v26, v66
    v_lshrrev_b32 v27, 16, v65
    s_mov_b64 exec, s[74:75]
    s_waitcnt lgkmcnt(0)
    v_cmp_gt_u32 vcc, 0x200000, v24
    v_and_b32 v24, 0xffff, v24
    s_andn2_b64 s[44:45], exec, vcc
    s_mov_b64 exec, vcc
    ds_write_b64 v24, v[60:61]
    s_cbranch_scc0 L_pl_21
    s_mov_b64 exec, s[44:45]
    v_mov_b32 v67, 0
    v_mov_b32 v71, 8
    ds_add_rtn_u32 v67, v67, v71 offset:52776
    s_waitcnt lgkmcnt(0)
    v_and_b32 v67, 2047, v67
    ds_write_b64 v67, v[60:61] offset:52800
L_pl_21:
    s_mov_b64 exec, s[76:77]
    v_cmp_gt_u32 vcc, 0x200000, v25
    v_and_b32 v25, 0xffff, v25
    s_andn2_b64 s[44:45], exec, vcc
    s_mov_b64 exec, vcc
    ds_write_b64 v25, v[22:23]
    s_cbranch_scc0 L_pl_23
    s_mov_b64 exec, s[44:45]
    v_mov_b32 v67, 0
    v_mov_b32 v71, 8
    ds_add_rtn_u32 v67, v67, v71 offset:52776
    s_waitcnt lgkmcnt(0)
    v_and_b32 v67, 2047, v67
    ds_write_b64 v67, v[22:23] offset:52800
L_pl_23:
    s_mov_b64 exec, s[78:79]
    v_cmp_gt_u32 vcc, 0x200000, v28
    v_and_b32 v28, 0xffff, v28
    s_andn2_b64 s[44:45], exec, vcc
    s_mov_b64 exec, vcc
    ds_write_b64 v28, v[64:65]
    s_cbranch_scc0 L_pl_25
    s_mov_b64 exec, s[44:45]
    v_mov_b32 v67, 0
    v_mov_b32 v71, 8
    ds_add_rtn_u32 v67, v67, v71 offset:52776
    s_waitcnt lgkmcnt(0)
    v_and_b32 v67, 2047, v67
    ds_write_b64 v67, v[64:65] offset:52800
L_pl_25:
    s_mov_b64 exec, s[80:81]
    v_cmp_gt_u32 vcc, 0x200000, v29
    v_and_b32 v29, 0xffff, v29
    s_andn2_b64 s[44:45], exec, vcc
    s_mov_b64 exec, vcc
    ds_write_b64 v29, v[26:27]
    s_cbranch_scc0 L_pl_27
    s_mov_b64 exec, s[44:45]
    v_mov_b32 v67, 0
    v_mov_b32 v71, 8
    ds_add_rtn_u32 v67, v67, v71 offset:52776
    s_waitcnt lgkmcnt(0)
    v_and_b32 v67, 2047, v67
    ds_write_b64 v67, v[26:27] offset:52800
L_pl_27:
    s_mov_b64 exec, -1
L_sc_20:
    s_cmp_lg_u32 s30, 2
    s_cbranch_scc1 L_k2_first
    s_mov_b32 s88, 0
    s_mov_b32 s31, s32
    s_add_u32 s32, s31, 384
    s_min_u32 s32, s32, s82
    s_add_u32 s88, s88, 149600
    s_mov_b32 s82, s83
    s_mov_b32 s83, s84
    s_mov_b32 s84, s85
    s_mov_b32 s85, s86
    s_mov_b32 s86, s87
    s_add_u32 s36, s31, 0
    v_add_u32 v22, s36, v0
    v_lshrrev_b32 v23, 5, v22
    v_lshl_add_u32 v23, v23, 3, s42
    ds_read_b64 v[44:45], v23 offset:0
    ds_read_b64 v[48:49], v23 offset:16
    ds_read_b64 v[52:53], v23 offset:32
    ds_read_b64 v[56:57], v23 offset:48
    v_not_b32 v24, v22
    v_mul_u32_u24 v25, 12, v22
    s_sub_i32 s35, s32, 0
    v_cmp_gt_i32 s[46:47], s35, v22
    s_waitcnt lgkmcnt(3)
    v_lshlrev_b32 v44, v24, v44
    v_bcnt_u32_b32 v44, v44, v45
    v_lshlrev_b32 v44, 2, v44
    ds_read_b32 v44, v44
    s_sub_i32 s35, s32, 64
    v_cmp_gt_i32 s[50:51], s35, v22
    s_waitcnt lgkmcnt(3)
    v_lshlrev_b32 v48, v24, v48
    v_bcnt_u32_b32 v48, v48, v49
    v_lshlrev_b32 v48, 2, v48
    ds_read_b32 v48, v48
    s_sub_i32 s35, s32, 128
    v_cmp_gt_i32 s[54:55], s35, v22
    s_waitcnt lgkmcnt(3)
    v_lshlrev_b32 v52, v24, v52
    v_bcnt_u32_b32 v52, v52, v53
    v_lshlrev_b32 v52, 2, v52
    ds_read_b32 v52, v52
    s_sub_i32 s35, s32, 192
    v_cmp_gt_i32 s[58:59], s35, v22
    s_waitcnt lgkmcnt(3)
    v_lshlrev_b32 v56, v24, v56
    v_bcnt_u32_b32 v56, v56, v57
    v_lshlrev_b32 v56, 2, v56
    ds_read_b32 v56, v56
    s_waitcnt lgkmcnt(3)
    v_add_u32 v44, v44, v25
    v_cndmask_b32 v44, -16, v44, s[46:47]
    buffer_load_dwordx3 v[44:46], v44, s[8:11], 0 offen offset:0
    s_waitcnt lgkmcnt(2)
    v_add_u32 v48, v48, v25
    v_cndmask_b32 v48, -16, v48, s[50:51]
    buffer_load_dwordx3 v[48:50], v48, s[8:11], 0 offen offset:768
    s_waitcnt lgkmcnt(1)
    v_add_u32 v52, v52, v25
    v_cndmask_b32 v52, -16, v52, s[54:55]
    buffer_load_dwordx3 v[52:54], v52, s[8:11], 0 offen offset:1536
    s_waitcnt lgkmcnt(0)
    v_add_u32 v56, v56, v25
    v_cndmask_b32 v56, -16, v56, s[58:59]
    buffer_load_dwordx3 v[56:58], v56, s[8:11], 0 offen offset:2304
    s_add_u32 s36, s31, 256
    v_add_u32 v22, s36, v0
    v_lshrrev_b32 v23, 5, v22
    v_lshl_add_u32 v23, v23, 3, s42
    ds_read_b64 v[60:61], v23 offset:0
    ds_read_b64 v[64:65], v23 offset:16
    v_not_b32 v24, v22
    v_mul_u32_u24 v25, 12, v22
    s_sub_i32 s35, s32, 0
    v_cmp_gt_i32 s[62:63], s35, v22
    s_waitcnt lgkmcnt(1)
    v_lshlrev_b32 v60, v24, v60
    v_bcnt_u32_b32 v60, v60, v61
    v_lshlrev_b32 v60, 2, v60
    ds_read_b32 v60, v60
    s_sub_i32 s35, s32, 64
    v_cmp_gt_i32 s[66:67], s35, v22
    s_waitcnt lgkmcnt(1)
    v_lshlrev_b32 v64, v24, v64
    v_bcnt_u32_b32 v64, v64, v65
    v_lshlrev_b32 v64, 2, v64
    ds_read_b32 v64, v64
    s_waitcnt lgkmcnt(1)
    v_add_u32 v60, v60, v25
    v_cndmask_b32 v60, -16, v60, s[62:63]
    buffer_load_dwordx3 v[60:62], v60, s[8:11], 0 offen offset:0
    s_waitcnt lgkmcnt(0)
    v_add_u32 v64, v64, v25
    v_cndmask_b32 v64, -16, v64, s[66:67]
    buffer_load_dwordx3 v[64:66], v64, s[8:11], 0 offen offset:768
L_k2_first:
    s_cmp_lg_u32 s28, 2
    s_cbranch_scc1 L_k2_nowts
    v_lshlrev_b32 v67, 4, v0
    s_mov_b32 exec_hi, 0
    s_mov_b32 m0, 132096
    s_nop 0
    global_load_lds_dwordx4 v67, s[98:99]
    s_mov_b32 m0, 132608
    s_nop 0
    global_load_lds_dwordx4 v67, s[100:101]
    s_mov_b32 exec_lo, 0xffff
    s_mov_b32 m0, 133120
    s_nop 0
    global_load_lds_dwordx4 v67, s[96:97]
    s_mov_b32 m0, 133376
    s_nop 0
    global_load_lds_dwordx4 v67, s[94:95]
    s_mov_b32 exec_lo, 1
    s_mov_b32 m0, 133632
    s_nop 0
    global_load_lds_dwordx4 v67, s[92:93]
    s_mov_b64 exec, -1
L_k2_nowts:
    s_setprio 0
    s_waitcnt lgkmcnt(0)
    s_barrier
    ds_read_b32 v22, v51 offset:52416
    ds_read_b64 v[30:31], v47 offset:44352
    s_mov_b32 s43, 1
    s_waitcnt lgkmcnt(0)
    v_cmp_ge_u32 vcc, v22, v5
    s_cmp_lg_u64 vcc, 0
    s_addc_u32 s43, s43, s43
    v_cndmask_b32 v30, -1, v30, vcc
    v_cndmask_b32 v31, 0, v31, vcc
    s_mov_b32 m0, s38
    v_lshl_or_b32 v9, v30, 5, 16
    s_nop 1
    v_and_b32_dpp v7, v9, v6 quad_perm:[0,0,2,2] row_mask:0xf bank_mask:0xf
    v_and_b32_dpp v8, v9, v6 quad_perm:[1,1,3,3] row_mask:0xf bank_mask:0xf
    buffer_load_dwordx4 v7, s[16:19], 0 offen lds
    s_add_u32 m0, s38, 1024
    s_nop 0
    buffer_load_dwordx4 v8, s[16:19], 0 offen lds
    ds_read_b32 v23, v51 offset:52304
    ds_read_b64 v[32:33], v47 offset:36960
    ds_read_b32 v24, v51 offset:52192
    ds_read_b64 v[34:35], v47 offset:29568
    s_waitcnt lgkmcnt(2)
    v_cmp_ge_u32 vcc, v23, v5
    s_cmp_lg_u64 vcc, 0
    s_addc_u32 s43, s43, s43
    v_cndmask_b32 v32, -1, v32, vcc
    v_cndmask_b32 v33, 0, v33, vcc
    s_waitcnt lgkmcnt(0)
    v_cmp_ge_u32 vcc, v24, v5
    s_cmp_lg_u64 vcc, 0
    s_addc_u32 s43, s43, s43
    v_cndmask_b32 v34, -1, v34, vcc
    v_cndmask_b32 v35, 0, v35, vcc
    s_lshl_b32 s37, s28, 9
    s_add_u32 s35, s37, s41
    v_mov_b32 v67, 0
    v_lshl_add_u32 v71, v0, 3, s35
    v_and_b32 v71, 2047, v71
    ds_read_b96 v[22:24], v67 offset:52768
    ds_read_b64 v[12:13], v71 offset:52800
    ds_read_b32 v25, v51 offset:52080
    ds_read_b64 v[36:37], v47 offset:22176
    ds_read_b32 v26, v51 offset:51968
    ds_read_b64 v[38:39], v47 offset:14784
    ds_read_b32 v27, v51 offset:51856
    ds_read_b64 v[40:41], v47 offset:7392
    ds_read_b32 v28, v51 offset:51744
    ds_read_b64 v[42:43], v47 offset:0
    s_mov_b64 exec, 0x3fff
    ds_write_b32 v59, v63 offset:51744
    s_mov_b64 exec, -1
    s_waitcnt lgkmcnt(7)
    v_cmp_ge_u32 vcc, v25, v5
    s_cmp_lg_u64 vcc, 0
    s_addc_u32 s43, s43, s43
    v_cndmask_b32 v36, -1, v36, vcc
    v_cndmask_b32 v37, 0, v37, vcc
    s_waitcnt lgkmcnt(5)
    v_cmp_ge_u32 vcc, v26, v5
    s_cmp_lg_u64 vcc, 0
    s_addc_u32 s43, s43, s43
    v_cndmask_b32 v38, -1, v38, vcc
    v_cndmask_b32 v39, 0, v39, vcc
    s_waitcnt lgkmcnt(3)
    v_cmp_ge_u32 vcc, v27, v5
    s_cmp_lg_u64 vcc, 0
    s_addc_u32 s43, s43, s43
    v_cndmask_b32 v40, -1, v40, vcc
    v_cndmask_b32 v41, 0, v41, vcc
    s_waitcnt lgkmcnt(1)
    v_cmp_ge_u32 vcc, v28, v5
    s_cmp_lg_u64 vcc, 0
    s_addc_u32 s43, s43, s43
    v_cndmask_b32 v42, -1, v42, vcc
    v_cndmask_b32 v43, 0, v43, vcc
    v_readfirstlane_b32 s35, v22
    v_readfirstlane_b32 s36, v23
    v_readfirstlane_b32 s34, v24
    s_cmp_lg_u32 s36, 0
    s_cbranch_scc1 L_k2_slow
    s_sub_u32 s36, s34, s41
    s_mov_b32 s41, s34
    s_cmp_gt_u32 s36, 2048
    s_cbranch_scc1 L_k2_slow
    s_sub_i32 s34, s36, s37
    s_ashr_i32 s34, s34, 3
    s_cmp_eq_u32 s35, s30
    s_cselect_b32 s36, 0x10000, s36
    s_add_u32 s30, s30, 1
    s_cmp_le_u32 s36, 256
    s_waitcnt lgkmcnt(0)
    s_barrier
    s_cbranch_scc1 L_k2_last
    s_bitcmp0_b32 s30, 0
    s_cbranch_scc1 L_k2_inB
    s_waitcnt vmcnt(2)
    s_branch L_k2_inA
L_k2_loopA0:
    s_waitcnt vmcnt(0)
    ds_read_b64_tr_b16 v[22:23], v3 offset:0
    ds_read_b64_tr_b16 v[24:25], v4 offset:0
    ds_read_b64_tr_b16 v[26:27], v3 offset:1024
    ds_read_b64_tr_b16 v[28:29], v4 offset:1024
    s_mov_b32 m0, s38
    s_waitcnt lgkmcnt(0)
    buffer_load_dwordx4 v7, s[16:19], 0 offen lds
    s_add_u32 m0, s38, 1024
    s_nop 0
    buffer_load_dwordx4 v8, s[16:19], 0 offen lds
    v_mfma_f32_16x16x32_bf16 v[120:123], v[22:25], v[14:17], v[120:123]
    v_mfma_f32_16x16x32_bf16 v[124:127], v[26:29], v[18:21], v[124:127]
L_k2_inA:
    v_and_b32_sdwa v9, s40, v30 dst_sel:DWORD dst_unused:UNUSED_PAD src0_sel:DWORD src1_sel:BYTE_2
    v_add_u32 v9, v9, v1
    ds_write_b16 v9, v31
    ds_read_b128 v[14:17], v2
    ds_read_b128 v[18:21], v2 offset:1024
    ds_write_b16 v9, v5
    s_cmp_le_i32 s34, 0
    s_cbranch_scc1 L_rt_29
    v_cmp_gt_u32 vcc, s34, v0
    s_mov_b64 exec, vcc
    v_lshlrev_b32_sdwa v9, 2, v12 dst_sel:DWORD dst_unused:UNUSED_PAD src0_sel:DWORD src1_sel:BYTE_3
    ds_add_rtn_u32 v9, v9, v55 offset:51744
    s_waitcnt lgkmcnt(0)
    v_cmp_gt_u32 vcc, 0x200000, v9
    v_and_b32 v9, 0xffff, v9
    s_andn2_b64 s[44:45], exec, vcc
    s_mov_b64 exec, vcc
    ds_write_b64 v9, v[12:13]
    s_cbranch_scc0 L_pl_31
    s_mov_b64 exec, s[44:45]
    v_mov_b32 v67, 0
    v_mov_b32 v71, 8
    ds_add_rtn_u32 v67, v67, v71 offset:52776
    s_waitcnt lgkmcnt(0)
    v_and_b32 v67, 2047, v67
    ds_write_b64 v67, v[12:13] offset:52800
L_pl_31:
    s_mov_b64 exec, -1
L_rt_29:
    s_mov_b64 s[48:49], s[46:47]
    s_mov_b64 s[52:53], s[50:51]
    s_cmp_eq_u64 s[46:47], 0
    s_cbranch_scc1 L_sc_33
    v_and_b32 v67, 0xfffff, v44
    v_and_b32 v71, 0xfffff, v46
    v_cmp_ne_u32 vcc, -1, v46
    v_cmp_gt_u32 s[74:75], s88, v67
    v_cmp_gt_u32 s[76:77], s88, v71
    s_and_b64 s[48:49], s[46:47], vcc
    s_and_b64 s[74:75], s[74:75], s[46:47]
    s_and_b64 s[76:77], s[76:77], s[48:49]
    s_andn2_b64 s[46:47], s[46:47], s[74:75]
    s_andn2_b64 s[48:49], s[48:49], s[76:77]
    v_and_b32 v67, 0xfffff, v48
    v_and_b32 v71, 0xfffff, v50
    v_cmp_ne_u32 vcc, -1, v50
    v_cmp_gt_u32 s[78:79], s88, v67
    v_cmp_gt_u32 s[80:81], s88, v71
    s_and_b64 s[52:53], s[50:51], vcc
    s_and_b64 s[78:79], s[78:79], s[50:51]
    s_and_b64 s[80:81], s[80:81], s[52:53]
    s_andn2_b64 s[50:51], s[50:51], s[78:79]
    s_andn2_b64 s[52:53], s[52:53], s[80:81]
    s_mov_b64 exec, s[74:75]
    v_lshlrev_b32_sdwa v24, 2, v44 dst_sel:DWORD dst_unused:UNUSED_PAD src0_sel:DWORD src1_sel:BYTE_3
    ds_add_rtn_u32 v24, v24, v55 offset:51744
    s_mov_b64 exec, s[76:77]
    v_lshlrev_b32_sdwa v25, 2, v46 dst_sel:DWORD dst_unused:UNUSED_PAD src0_sel:DWORD src1_sel:BYTE_3
    ds_add_rtn_u32 v25, v25, v55 offset:51744
    v_mov_b32 v22, v46
    v_lshrrev_b32 v23, 16, v45
    s_mov_b64 exec, s[78:79]
    v_lshlrev_b32_sdwa v28, 2, v48 dst_sel:DWORD dst_unused:UNUSED_PAD src0_sel:DWORD src1_sel:BYTE_3
    ds_add_rtn_u32 v28, v28, v55 offset:51744
    s_mov_b64 exec, s[80:81]
    v_lshlrev_b32_sdwa v29, 2, v50 dst_sel:DWORD dst_unused:UNUSED_PAD src0_sel:DWORD src1_sel:BYTE_3
    ds_add_rtn_u32 v29, v29, v55 offset:51744
    v_mov_b32 v26, v50
    v_lshrrev_b32 v27, 16, v49
    s_mov_b64 exec, s[74:75]
    s_waitcnt lgkmcnt(0)
    v_cmp_gt_u32 vcc, 0x200000, v24
    v_and_b32 v24, 0xffff, v24
    s_andn2_b64 s[44:45], exec, vcc
    s_mov_b64 exec, vcc
    ds_write_b64 v24, v[44:45]
    s_cbranch_scc0 L_pl_34
    s_mov_b64 exec, s[44:45]
    v_mov_b32 v67, 0
    v_mov_b32 v71, 8
    ds_add_rtn_u32 v67, v67, v71 offset:52776
    s_waitcnt lgkmcnt(0)
    v_and_b32 v67, 2047, v67
    ds_write_b64 v67, v[44:45] offset:52800
L_pl_34:
    s_mov_b64 exec, s[76:77]
    v_cmp_gt_u32 vcc, 0x200000, v25
    v_and_b32 v25, 0xffff, v25
    s_andn2_b64 s[44:45], exec, vcc
    s_mov_b64 exec, vcc
    ds_write_b64 v25, v[22:23]
    s_cbranch_scc0 L_pl_36
    s_mov_b64 exec, s[44:45]
    v_mov_b32 v67, 0
    v_mov_b32 v71, 8
    ds_add_rtn_u32 v67, v67, v71 offset:52776
    s_waitcnt lgkmcnt(0)
    v_and_b32 v67, 2047, v67
    ds_write_b64 v67, v[22:23] offset:52800
L_pl_36:
    s_mov_b64 exec, s[78:79]
    v_cmp_gt_u32 vcc, 0x200000, v28
    v_and_b32 v28, 0xffff, v28
    s_andn2_b64 s[44:45], exec, vcc
    s_mov_b64 exec, vcc
    ds_write_b64 v28, v[48:49]
    s_cbranch_scc0 L_pl_38
    s_mov_b64 exec, s[44:45]
    v_mov_b32 v67, 0
    v_mov_b32 v71, 8
    ds_add_rtn_u32 v67, v67, v71 offset:52776
    s_waitcnt lgkmcnt(0)
    v_and_b32 v67, 2047, v67
    ds_write_b64 v67, v[48:49] offset:52800
L_pl_38:
    s_mov_b64 exec, s[80:81]
    v_cmp_gt_u32 vcc, 0x200000, v29
    v_and_b32 v29, 0xffff, v29
    s_andn2_b64 s[44:45], exec, vcc
    s_mov_b64 exec, vcc
    ds_write_b64 v29, v[26:27]
    s_cbranch_scc0 L_pl_40
    s_mov_b64 exec, s[44:45]
    v_mov_b32 v67, 0
    v_mov_b32 v71, 8
    ds_add_rtn_u32 v67, v67, v71 offset:52776
    s_waitcnt lgkmcnt(0)
    v_and_b32 v67, 2047, v67
    ds_write_b64 v67, v[26:27] offset:52800
L_pl_40:
    s_mov_b64 exec, -1
L_sc_33:
    v_lshl_or_b32 v9, v32, 5, 16
    s_nop 1
    v_and_b32_dpp v7, v9, v6 quad_perm:[0,0,2,2] row_mask:0xf bank_mask:0xf
    v_and_b32_dpp v8, v9, v6 quad_perm:[1,1,3,3] row_mask:0xf bank_mask:0xf
    s_waitcnt vmcnt(0)
    ds_read_b64_tr_b16 v[22:23], v3 offset:0
    ds_read_b64_tr_b16 v[24:25], v4 offset:0
    ds_read_b64_tr_b16 v[26:27], v3 offset:1024
    ds_read_b64_tr_b16 v[28:29], v4 offset:1024
    s_mov_b32 m0, s38
    s_waitcnt lgkmcnt(0)
    buffer_load_dwordx4 v7, s[16:19], 0 offen lds
    s_add_u32 m0, s38, 1024
    s_nop 0
    buffer_load_dwordx4 v8, s[16:19], 0 offen lds
    v_mfma_f32_16x16x32_bf16 v[72:75], v[22:25], v[14:17], v[72:75]
    v_mfma_f32_16x16x32_bf16 v[76:79], v[26:29], v[18:21], v[76:79]
    v_and_b32_sdwa v9, s40, v32 dst_sel:DWORD dst_unused:UNUSED_PAD src0_sel:DWORD src1_sel:BYTE_2
    v_add_u32 v9, v9, v1
    ds_write_b16 v9, v33
    ds_read_b128 v[14:17], v2
    ds_read_b128 v[18:21], v2 offset:1024
    ds_write_b16 v9, v5
    s_mov_b64 s[56:57], s[54:55]
    s_mov_b64 s[60:61], s[58:59]
    s_cmp_eq_u64 s[54:55], 0
    s_cbranch_scc1 L_sc_42
    v_and_b32 v67, 0xfffff, v52
    v_and_b32 v71, 0xfffff, v54
    v_cmp_ne_u32 vcc, -1, v54
    v_cmp_gt_u32 s[74:75], s88, v67
    v_cmp_gt_u32 s[76:77], s88, v71
    s_and_b64 s[56:57], s[54:55], vcc
    s_and_b64 s[74:75], s[74:75], s[54:55]
    s_and_b64 s[76:77], s[76:77], s[56:57]
    s_andn2_b64 s[54:55], s[54:55], s[74:75]
    s_andn2_b64 s[56:57], s[56:57], s[76:77]
    v_and_b32 v67, 0xfffff, v56
    v_and_b32 v71, 0xfffff, v58
    v_cmp_ne_u32 vcc, -1, v58
    v_cmp_gt_u32 s[78:79], s88, v67
    v_cmp_gt_u32 s[80:81], s88, v71
    s_and_b64 s[60:61], s[58:59], vcc
    s_and_b64 s[78:79], s[78:79], s[58:59]
    s_and_b64 s[80:81], s[80:81], s[60:61]
    s_andn2_b64 s[58:59], s[58:59], s[78:79]
    s_andn2_b64 s[60:61], s[60:61], s[80:81]
    s_mov_b64 exec, s[74:75]
    v_lshlrev_b32_sdwa v24, 2, v52 dst_sel:DWORD dst_unused:UNUSED_PAD src0_sel:DWORD src1_sel:BYTE_3
    ds_add_rtn_u32 v24, v24, v55 offset:51744
    s_mov_b64 exec, s[76:77]
    v_lshlrev_b32_sdwa v25, 2, v54 dst_sel:DWORD dst_unused:UNUSED_PAD src0_sel:DWORD src1_sel:BYTE_3
    ds_add_rtn_u32 v25, v25, v55 offset:51744
    v_mov_b32 v22, v54
    v_lshrrev_b32 v23, 16, v53
    s_mov_b64 exec, s[78:79]
    v_lshlrev_b32_sdwa v28, 2, v56 dst_sel:DWORD dst_unused:UNUSED_PAD src0_sel:DWORD src1_sel:BYTE_3
    ds_add_rtn_u32 v28, v28, v55 offset:51744
    s_mov_b64 exec, s[80:81]
    v_lshlrev_b32_sdwa v29, 2, v58 dst_sel:DWORD dst_unused:UNUSED_PAD src0_sel:DWORD src1_sel:BYTE_3
    ds_add_rtn_u32 v29, v29, v55 offset:51744
    v_mov_b32 v26, v58
    v_lshrrev_b32 v27, 16, v57
    s_mov_b64 exec, s[74:75]
    s_waitcnt lgkmcnt(0)
    v_cmp_gt_u32 vcc, 0x200000, v24
    v_and_b32 v24, 0xffff, v24
    s_andn2_b64 s[44:45], exec, vcc
    s_mov_b64 exec, vcc
    ds_write_b64 v24, v[52:53]
    s_cbranch_scc0 L_pl_43
    s_mov_b64 exec, s[44:45]
    v_mov_b32 v67, 0
    v_mov_b32 v71, 8
    ds_add_rtn_u32 v67, v67, v71 offset:52776
    s_waitcnt lgkmcnt(0)
    v_and_b32 v67, 2047, v67
    ds_write_b64 v67, v[52:53] offset:52800
L_pl_43:
    s_mov_b64 exec, s[76:77]
    v_cmp_gt_u32 vcc, 0x200000, v25
    v_and_b32 v25, 0xffff, v25
    s_andn2_b64 s[44:45], exec, vcc
    s_mov_b64 exec, vcc
    ds_write_b64 v25, v[22:23]
    s_cbranch_scc0 L_pl_45
    s_mov_b64 exec, s[44:45]
    v_mov_b32 v67, 0
    v_mov_b32 v71, 8
    ds_add_rtn_u32 v67, v67, v71 offset:52776
    s_waitcnt lgkmcnt(0)
    v_and_b32 v67, 2047, v67
    ds_write_b64 v67, v[22:23] offset:52800
L_pl_45:
    s_mov_b64 exec, s[78:79]
    v_cmp_gt_u32 vcc, 0x200000, v28
    v_and_b32 v28, 0xffff, v28
    s_andn2_b64 s[44:45], exec, vcc
    s_mov_b64 exec, vcc
    ds_write_b64 v28, v[56:57]
    s_cbranch_scc0 L_pl_47
    s_mov_b64 exec, s[44:45]
    v_mov_b32 v67, 0
    v_mov_b32 v71, 8
    ds_add_rtn_u32 v67, v67, v71 offset:52776
    s_waitcnt lgkmcnt(0)
    v_and_b32 v67, 2047, v67
    ds_write_b64 v67, v[56:57] offset:52800
L_pl_47:
    s_mov_b64 exec, s[80:81]
    v_cmp_gt_u32 vcc, 0x200000, v29
    v_and_b32 v29, 0xffff, v29
    s_andn2_b64 s[44:45], exec, vcc
    s_mov_b64 exec, vcc
    ds_write_b64 v29, v[26:27]
    s_cbranch_scc0 L_pl_49
    s_mov_b64 exec, s[44:45]
    v_mov_b32 v67, 0
    v_mov_b32 v71, 8
    ds_add_rtn_u32 v67, v67, v71 offset:52776
    s_waitcnt lgkmcnt(0)
    v_and_b32 v67, 2047, v67
    ds_write_b64 v67, v[26:27] offset:52800
L_pl_49:
    s_mov_b64 exec, -1
L_sc_42:
    v_lshl_or_b32 v9, v34, 5, 16
    s_nop 1
    v_and_b32_dpp v7, v9, v6 quad_perm:[0,0,2,2] row_mask:0xf bank_mask:0xf
    v_and_b32_dpp v8, v9, v6 quad_perm:[1,1,3,3] row_mask:0xf bank_mask:0xf
    s_waitcnt vmcnt(0)
    ds_read_b64_tr_b16 v[22:23], v3 offset:0
    ds_read_b64_tr_b16 v[24:25], v4 offset:0
    ds_read_b64_tr_b16 v[26:27], v3 offset:1024
    ds_read_b64_tr_b16 v[28:29], v4 offset:1024
    s_mov_b32 m0, s38
    s_waitcnt lgkmcnt(0)
    buffer_load_dwordx4 v7, s[16:19], 0 offen lds
    s_add_u32 m0, s38, 1024
    s_nop 0
    buffer_load_dwordx4 v8, s[16:19], 0 offen lds
    v_mfma_f32_16x16x32_bf16 v[80:83], v[22:25], v[14:17], v[80:83]
    v_mfma_f32_16x16x32_bf16 v[84:87], v[26:29], v[18:21], v[84:87]
    v_and_b32_sdwa v9, s40, v34 dst_sel:DWORD dst_unused:UNUSED_PAD src0_sel:DWORD src1_sel:BYTE_2
    v_add_u32 v9, v9, v1
    ds_write_b16 v9, v35
    ds_read_b128 v[14:17], v2
    ds_read_b128 v[18:21], v2 offset:1024
    ds_write_b16 v9, v5
    s_mov_b64 s[64:65], s[62:63]
    s_cmp_eq_u64 s[62:63], 0
    s_cbranch_scc1 L_sc_51
    v_and_b32 v67, 0xfffff, v60
    v_and_b32 v71, 0xfffff, v62
    v_cmp_ne_u32 vcc, -1, v62
    v_cmp_gt_u32 s[74:75], s88, v67
    v_cmp_gt_u32 s[76:77], s88, v71
    s_and_b64 s[64:65], s[62:63], vcc
    s_and_b64 s[74:75], s[74:75], s[62:63]
    s_and_b64 s[76:77], s[76:77], s[64:65]
    s_andn2_b64 s[62:63], s[62:63], s[74:75]
    s_andn2_b64 s[64:65], s[64:65], s[76:77]
    s_mov_b64 exec, s[74:75]
    v_lshlrev_b32_sdwa v24, 2, v60 dst_sel:DWORD dst_unused:UNUSED_PAD src0_sel:DWORD src1_sel:BYTE_3
    ds_add_rtn_u32 v24, v24, v55 offset:51744
    s_mov_b64 exec, s[76:77]
    v_lshlrev_b32_sdwa v25, 2, v62 dst_sel:DWORD dst_unused:UNUSED_PAD src0_sel:DWORD src1_sel:BYTE_3
    ds_add_rtn_u32 v25, v25, v55 offset:51744
    v_mov_b32 v22, v62
    v_lshrrev_b32 v23, 16, v61
    s_mov_b64 exec, s[74:75]
    s_waitcnt lgkmcnt(0)
    v_cmp_gt_u32 vcc, 0x200000, v24
    v_and_b32 v24, 0xffff, v24
    s_andn2_b64 s[44:45], exec, vcc
    s_mov_b64 exec, vcc
    ds_write_b64 v24, v[60:61]
    s_cbranch_scc0 L_pl_52
    s_mov_b64 exec, s[44:45]
    v_mov_b32 v67, 0
    v_mov_b32 v71, 8
    ds_add_rtn_u32 v67, v67, v71 offset:52776
    s_waitcnt lgkmcnt(0)
    v_and_b32 v67, 2047, v67
    ds_write_b64 v67, v[60:61] offset:52800
L_pl_52:
    s_mov_b64 exec, s[76:77]
    v_cmp_gt_u32 vcc, 0x200000, v25
    v_and_b32 v25, 0xffff, v25
    s_andn2_b64 s[44:45], exec, vcc
    s_mov_b64 exec, vcc
    ds_write_b64 v25, v[22:23]
    s_cbranch_scc0 L_pl_54
    s_mov_b64 exec, s[44:45]
    v_mov_b32 v67, 0
    v_mov_b32 v71, 8
    ds_add_rtn_u32 v67, v67, v71 offset:52776
    s_waitcnt lgkmcnt(0)
    v_and_b32 v67, 2047, v67
    ds_write_b64 v67, v[22:23] offset:52800
L_pl_54:
    s_mov_b64 exec, -1
L_sc_51:
    v_lshl_or_b32 v9, v36, 5, 16
    s_nop 1
    v_and_b32_dpp v7, v9, v6 quad_perm:[0,0,2,2] row_mask:0xf bank_mask:0xf
    v_and_b32_dpp v8, v9, v6 quad_perm:[1,1,3,3] row_mask:0xf bank_mask:0xf
    s_waitcnt vmcnt(0)
    ds_read_b64_tr_b16 v[22:23], v3 offset:0
    ds_read_b64_tr_b16 v[24:25], v4 offset:0
    ds_read_b64_tr_b16 v[26:27], v3 offset:1024
    ds_read_b64_tr_b16 v[28:29], v4 offset:1024
    s_mov_b32 m0, s38
    s_waitcnt lgkmcnt(0)
    buffer_load_dwordx4 v7, s[16:19], 0 offen lds
    s_add_u32 m0, s38, 1024
    s_nop 0
    buffer_load_dwordx4 v8, s[16:19], 0 offen lds
    v_mfma_f32_16x16x32_bf16 v[88:91], v[22:25], v[14:17], v[88:91]
    v_mfma_f32_16x16x32_bf16 v[92:95], v[26:29], v[18:21], v[92:95]
    v_and_b32_sdwa v9, s40, v36 dst_sel:DWORD dst_unused:UNUSED_PAD src0_sel:DWORD src1_sel:BYTE_2
    v_add_u32 v9, v9, v1
    ds_write_b16 v9, v37
    ds_read_b128 v[14:17], v2
    ds_read_b128 v[18:21], v2 offset:1024
    ds_write_b16 v9, v5
    s_mov_b64 s[68:69], s[66:67]
    s_cmp_eq_u64 s[66:67], 0
    s_cbranch_scc1 L_sc_56
    v_and_b32 v67, 0xfffff, v64
    v_and_b32 v71, 0xfffff, v66
    v_cmp_ne_u32 vcc, -1, v66
    v_cmp_gt_u32 s[74:75], s88, v67
    v_cmp_gt_u32 s[76:77], s88, v71
    s_and_b64 s[68:69], s[66:67], vcc
    s_and_b64 s[74:75], s[74:75], s[66:67]
    s_and_b64 s[76:77], s[76:77], s[68:69]
    s_andn2_b64 s[66:67], s[66:67], s[74:75]
    s_andn2_b64 s[68:69], s[68:69], s[76:77]
    s_mov_b64 exec, s[74:75]
    v_lshlrev_b32_sdwa v24, 2, v64 dst_sel:DWORD dst_unused:UNUSED_PAD src0_sel:DWORD src1_sel:BYTE_3
    ds_add_rtn_u32 v24, v24, v55 offset:51744
    s_mov_b64 exec, s[76:77]
    v_lshlrev_b32_sdwa v25, 2, v66 dst_sel:DWORD dst_unused:UNUSED_PAD src0_sel:DWORD src1_sel:BYTE_3
    ds_add_rtn_u32 v25, v25, v55 offset:51744
    v_mov_b32 v22, v66
    v_lshrrev_b32 v23, 16, v65
    s_mov_b64 exec, s[74:75]
    s_waitcnt lgkmcnt(0)
    v_cmp_gt_u32 vcc, 0x200000, v24
    v_and_b32 v24, 0xffff, v24
    s_andn2_b64 s[44:45], exec, vcc
    s_mov_b64 exec, vcc
    ds_write_b64 v24, v[64:65]
    s_cbranch_scc0 L_pl_57
    s_mov_b64 exec, s[44:45]
    v_mov_b32 v67, 0
    v_mov_b32 v71, 8
    ds_add_rtn_u32 v67, v67, v71 offset:52776
    s_waitcnt lgkmcnt(0)
    v_and_b32 v67, 2047, v67
    ds_write_b64 v67, v[64:65] offset:52800
L_pl_57:
    s_mov_b64 exec, s[76:77]
    v_cmp_gt_u32 vcc, 0x200000, v25
    v_and_b32 v25, 0xffff, v25
    s_andn2_b64 s[44:45], exec, vcc
    s_mov_b64 exec, vcc
    ds_write_b64 v25, v[22:23]
    s_cbranch_scc0 L_pl_59
    s_mov_b64 exec, s[44:45]
    v_mov_b32 v67, 0
    v_mov_b32 v71, 8
    ds_add_rtn_u32 v67, v67, v71 offset:52776
    s_waitcnt lgkmcnt(0)
    v_and_b32 v67, 2047, v67
    ds_write_b64 v67, v[22:23] offset:52800
L_pl_59:
    s_mov_b64 exec, -1
L_sc_56:
    v_lshl_or_b32 v9, v38, 5, 16
    s_nop 1
    v_and_b32_dpp v7, v9, v6 quad_perm:[0,0,2,2] row_mask:0xf bank_mask:0xf
    v_and_b32_dpp v8, v9, v6 quad_perm:[1,1,3,3] row_mask:0xf bank_mask:0xf
    s_waitcnt vmcnt(0)
    ds_read_b64_tr_b16 v[22:23], v3 offset:0
    ds_read_b64_tr_b16 v[24:25], v4 offset:0
    ds_read_b64_tr_b16 v[26:27], v3 offset:1024
    ds_read_b64_tr_b16 v[28:29], v4 offset:1024
    s_mov_b32 m0, s38
    s_waitcnt lgkmcnt(0)
    buffer_load_dwordx4 v7, s[16:19], 0 offen lds
    s_add_u32 m0, s38, 1024
    s_nop 0
    buffer_load_dwordx4 v8, s[16:19], 0 offen lds
    v_mfma_f32_16x16x32_bf16 v[96:99], v[22:25], v[14:17], v[96:99]
    v_mfma_f32_16x16x32_bf16 v[100:103], v[26:29], v[18:21], v[100:103]
    v_and_b32_sdwa v9, s40, v38 dst_sel:DWORD dst_unused:UNUSED_PAD src0_sel:DWORD src1_sel:BYTE_2
    v_add_u32 v9, v9, v1
    ds_write_b16 v9, v39
    ds_read_b128 v[14:17], v2
    ds_read_b128 v[18:21], v2 offset:1024
    ds_write_b16 v9, v5
    s_or_b64 s[44:45], s[46:47], s[48:49]
    s_or_b64 s[44:45], s[44:45], s[50:51]
    s_or_b64 s[44:45], s[44:45], s[52:53]
    s_or_b64 s[44:45], s[44:45], s[54:55]
    s_or_b64 s[44:45], s[44:45], s[56:57]
    s_or_b64 s[44:45], s[44:45], s[58:59]
    s_or_b64 s[44:45], s[44:45], s[60:61]
    s_or_b64 s[44:45], s[44:45], s[62:63]
    s_or_b64 s[44:45], s[44:45], s[64:65]
    s_or_b64 s[44:45], s[44:45], s[66:67]
    s_or_b64 s[44:45], s[44:45], s[68:69]
    s_cselect_b32 s36, 0, s32
    s_cmp_ge_u32 s36, s33
    s_cbranch_scc1 L_fl_61
    v_mov_b32 v67, 0
    v_mov_b32 v71, s30
    ds_write_b32 v67, v71 offset:52768
L_fl_61:
    v_lshl_or_b32 v9, v40, 5, 16
    s_nop 1
    v_and_b32_dpp v7, v9, v6 quad_perm:[0,0,2,2] row_mask:0xf bank_mask:0xf
    v_and_b32_dpp v8, v9, v6 quad_perm:[1,1,3,3] row_mask:0xf bank_mask:0xf
    s_waitcnt lgkmcnt(0)
    s_barrier
    s_waitcnt vmcnt(0)
    ds_read_b64_tr_b16 v[22:23], v3 offset:0
    ds_read_b64_tr_b16 v[24:25], v4 offset:0
    ds_read_b64_tr_b16 v[26:27], v3 offset:1024
    ds_read_b64_tr_b16 v[28:29], v4 offset:1024
    s_mov_b32 m0, s38
    s_waitcnt lgkmcnt(0)
    buffer_load_dwordx4 v7, s[16:19], 0 offen lds
    s_add_u32 m0, s38, 1024
    s_nop 0
    buffer_load_dwordx4 v8, s[16:19], 0 offen lds
    v_mfma_f32_16x16x32_bf16 v[104:107], v[22:25], v[14:17], v[104:107]
    v_mfma_f32_16x16x32_bf16 v[108:111], v[26:29], v[18:21], v[108:111]
    v_and_b32_sdwa v9, s40, v40 dst_sel:DWORD dst_unused:UNUSED_PAD src0_sel:DWORD src1_sel:BYTE_2
    v_add_u32 v9, v9, v1
    ds_write_b16 v9, v41
    ds_read_b128 v[14:17], v2
    ds_read_b128 v[18:21], v2 offset:1024
    ds_write_b16 v9, v5
    ds_read_b32 v22, v51 offset:52416
    ds_read_b64 v[30:31], v47 offset:44352
    ds_read_b32 v23, v51 offset:52304
    ds_read_b64 v[32:33], v47 offset:36960
    ds_read_b32 v24, v51 offset:52192
    ds_read_b64 v[34:35], v47 offset:29568
    ds_read_b32 v25, v51 offset:52080
    ds_read_b64 v[36:37], v47 offset:22176
    ds_read_b32 v26, v51 offset:51968
    ds_read_b64 v[38:39], v47 offset:14784
    ds_read_b32 v27, v51 offset:51856
    ds_read_b64 v[40:41], v47 offset:7392
    s_mov_b32 s43, 1
    s_waitcnt lgkmcnt(10)
    v_cmp_ge_u32 vcc, v22, v5
    s_cmp_lg_u64 vcc, 0
    s_addc_u32 s43, s43, s43
    v_cndmask_b32 v30, -1, v30, vcc
    v_cndmask_b32 v31, 0, v31, vcc
    s_waitcnt lgkmcnt(8)
    v_cmp_ge_u32 vcc, v23, v5
    s_cmp_lg_u64 vcc, 0
    s_addc_u32 s43, s43, s43
    v_cndmask_b32 v32, -1, v32, vcc
    v_cndmask_b32 v33, 0, v33, vcc
    s_waitcnt lgkmcnt(6)
    v_cmp_ge_u32 vcc, v24, v5
    s_cmp_lg_u64 vcc, 0
    s_addc_u32 s43, s43, s43
    v_cndmask_b32 v34, -1, v34, vcc
    v_cndmask_b32 v35, 0, v35, vcc
    s_waitcnt lgkmcnt(4)
    v_cmp_ge_u32 vcc, v25, v5
    s_cmp_lg_u64 vcc, 0
    s_addc_u32 s43, s43, s43
    v_cndmask_b32 v36, -1, v36, vcc
    v_cndmask_b32 v37, 0, v37, vcc
    s_waitcnt lgkmcnt(2)
    v_cmp_ge_u32 vcc, v26, v5
    s_cmp_lg_u64 vcc, 0
    s_addc_u32 s43, s43, s43
    v_cndmask_b32 v38, -1, v38, vcc
    v_cndmask_b32 v39, 0, v39, vcc
    s_waitcnt lgkmcnt(0)
    v_cmp_ge_u32 vcc, v27, v5
    s_cmp_lg_u64 vcc, 0
    s_addc_u32 s43, s43, s43
    v_cndmask_b32 v40, -1, v40, vcc
    v_cndmask_b32 v41, 0, v41, vcc
    v_lshl_or_b32 v9, v42, 5, 16
    s_nop 1
    v_and_b32_dpp v7, v9, v6 quad_perm:[0,0,2,2] row_mask:0xf bank_mask:0xf
    v_and_b32_dpp v8, v9, v6 quad_perm:[1,1,3,3] row_mask:0xf bank_mask:0xf
    s_waitcnt vmcnt(0)
    ds_read_b64_tr_b16 v[22:23], v3 offset:0
    ds_read_b64_tr_b16 v[24:25], v4 offset:0
    ds_read_b64_tr_b16 v[26:27], v3 offset:1024
    ds_read_b64_tr_b16 v[28:29], v4 offset:1024
    s_mov_b32 m0, s38
    s_waitcnt lgkmcnt(0)
    buffer_load_dwordx4 v7, s[16:19], 0 offen lds
    s_add_u32 m0, s38, 1024
    s_nop 0
    buffer_load_dwordx4 v8, s[16:19], 0 offen lds
    v_mfma_f32_16x16x32_bf16 v[112:115], v[22:25], v[14:17], v[112:115]
    v_mfma_f32_16x16x32_bf16 v[116:119], v[26:29], v[18:21], v[116:119]
    v_and_b32_sdwa v9, s40, v42 dst_sel:DWORD dst_unused:UNUSED_PAD src0_sel:DWORD src1_sel:BYTE_2
    v_add_u32 v9, v9, v1
    ds_write_b16 v9, v43
    ds_read_b128 v[14:17], v2
    ds_read_b128 v[18:21], v2 offset:1024
    ds_write_b16 v9, v5
    s_lshl_b32 s37, s28, 9
    s_add_u32 s35, s37, s41
    v_mov_b32 v67, 0
    v_lshl_add_u32 v71, v0, 3, s35
    v_and_b32 v71, 2047, v71
    ds_read_b96 v[22:24], v67 offset:52768
    ds_read_b64 v[12:13], v71 offset:52800
    ds_read_b32 v28, v51 offset:51744
    ds_read_b64 v[42:43], v47 offset:0
    s_mov_b64 exec, 0x3fff
    ds_write_b32 v59, v63 offset:51744
    s_mov_b64 exec, -1
    s_waitcnt lgkmcnt(1)
    v_cmp_ge_u32 vcc, v28, v5
    s_cmp_lg_u64 vcc, 0
    s_addc_u32 s43, s43, s43
    v_cndmask_b32 v42, -1, v42, vcc
    v_cndmask_b32 v43, 0, v43, vcc
    s_branch L_k2_tail
L_k2_loopB0:
    s_waitcnt vmcnt(0)
    ds_read_b64_tr_b16 v[22:23], v3 offset:0
    ds_read_b64_tr_b16 v[24:25], v4 offset:0
    ds_read_b64_tr_b16 v[26:27], v3 offset:1024
    ds_read_b64_tr_b16 v[28:29], v4 offset:1024
    s_mov_b32 m0, s38
    s_waitcnt lgkmcnt(0)
    buffer_load_dwordx4 v7, s[16:19], 0 offen lds
    s_add_u32 m0, s38, 1024
    s_nop 0
    buffer_load_dwordx4 v8, s[16:19], 0 offen lds
    v_mfma_f32_16x16x32_bf16 v[120:123], v[22:25], v[14:17], v[120:123]
    v_mfma_f32_16x16x32_bf16 v[124:127], v[26:29], v[18:21], v[124:127]
L_k2_inB:
    v_and_b32_sdwa v9, s40, v30 dst_sel:DWORD dst_unused:UNUSED_PAD src0_sel:DWORD src1_sel:BYTE_2
    v_add_u32 v9, v9, v1
    ds_write_b16 v9, v31
    ds_read_b128 v[14:17], v2
    ds_read_b128 v[18:21], v2 offset:1024
    ds_write_b16 v9, v5
    s_cmp_le_i32 s34, 0
    s_cbranch_scc1 L_rt_62
    v_cmp_gt_u32 vcc, s34, v0
    s_mov_b64 exec, vcc
    v_lshlrev_b32_sdwa v9, 2, v12 dst_sel:DWORD dst_unused:UNUSED_PAD src0_sel:DWORD src1_sel:BYTE_3
    ds_add_rtn_u32 v9, v9, v55 offset:51744
    s_waitcnt lgkmcnt(0)
    v_cmp_gt_u32 vcc, 0x200000, v9
    v_and_b32 v9, 0xffff, v9
    s_andn2_b64 s[44:45], exec, vcc
    s_mov_b64 exec, vcc
    ds_write_b64 v9, v[12:13]
    s_cbranch_scc0 L_pl_64
    s_mov_b64 exec, s[44:45]
    v_mov_b32 v67, 0
    v_mov_b32 v71, 8
    ds_add_rtn_u32 v67, v67, v71 offset:52776
    s_waitcnt lgkmcnt(0)
    v_and_b32 v67, 2047, v67
    ds_write_b64 v67, v[12:13] offset:52800
L_pl_64:
    s_mov_b64 exec, -1
L_rt_62:
    s_or_b64 s[44:45], s[46:47], s[48:49]
    s_or_b64 s[44:45], s[44:45], s[50:51]
    s_or_b64 s[44:45], s[44:45], s[52:53]
    s_cbranch_scc0 L_sc_66
    s_mov_b64 exec, s[46:47]
    v_lshlrev_b32_sdwa v24, 2, v44 dst_sel:DWORD dst_unused:UNUSED_PAD src0_sel:DWORD src1_sel:BYTE_3
    ds_add_rtn_u32 v24, v24, v55 offset:51744
    s_mov_b64 exec, s[48:49]
    v_lshlrev_b32_sdwa v25, 2, v46 dst_sel:DWORD dst_unused:UNUSED_PAD src0_sel:DWORD src1_sel:BYTE_3
    ds_add_rtn_u32 v25, v25, v55 offset:51744
    v_mov_b32 v22, v46
    v_lshrrev_b32 v23, 16, v45
    s_mov_b64 exec, s[50:51]
    v_lshlrev_b32_sdwa v28, 2, v48 dst_sel:DWORD dst_unused:UNUSED_PAD src0_sel:DWORD src1_sel:BYTE_3
    ds_add_rtn_u32 v28, v28, v55 offset:51744
    s_mov_b64 exec, s[52:53]
    v_lshlrev_b32_sdwa v29, 2, v50 dst_sel:DWORD dst_unused:UNUSED_PAD src0_sel:DWORD src1_sel:BYTE_3
    ds_add_rtn_u32 v29, v29, v55 offset:51744
    v_mov_b32 v26, v50
    v_lshrrev_b32 v27, 16, v49
    s_mov_b64 exec, s[46:47]
    s_waitcnt lgkmcnt(0)
    v_cmp_gt_u32 vcc, 0x200000, v24
    v_and_b32 v24, 0xffff, v24
    s_andn2_b64 s[44:45], exec, vcc
    s_mov_b64 exec, vcc
    ds_write_b64 v24, v[44:45]
    s_cbranch_scc0 L_pl_67
    s_mov_b64 exec, s[44:45]
    v_mov_b32 v67, 0
    v_mov_b32 v71, 8
    ds_add_rtn_u32 v67, v67, v71 offset:52776
    s_waitcnt lgkmcnt(0)
    v_and_b32 v67, 2047, v67
    ds_write_b64 v67, v[44:45] offset:52800
L_pl_67:
    s_mov_b64 exec, s[48:49]
    v_cmp_gt_u32 vcc, 0x200000, v25
    v_and_b32 v25, 0xffff, v25
    s_andn2_b64 s[44:45], exec, vcc
    s_mov_b64 exec, vcc
    ds_write_b64 v25, v[22:23]
    s_cbranch_scc0 L_pl_69
    s_mov_b64 exec, s[44:45]
    v_mov_b32 v67, 0
    v_mov_b32 v71, 8
    ds_add_rtn_u32 v67, v67, v71 offset:52776
    s_waitcnt lgkmcnt(0)
    v_and_b32 v67, 2047, v67
    ds_write_b64 v67, v[22:23] offset:52800
L_pl_69:
    s_mov_b64 exec, s[50:51]
    v_cmp_gt_u32 vcc, 0x200000, v28
    v_and_b32 v28, 0xffff, v28
    s_andn2_b64 s[44:45], exec, vcc
    s_mov_b64 exec, vcc
    ds_write_b64 v28, v[48:49]
    s_cbranch_scc0 L_pl_71
    s_mov_b64 exec, s[44:45]
    v_mov_b32 v67, 0
    v_mov_b32 v71, 8
    ds_add_rtn_u32 v67, v67, v71 offset:52776
    s_waitcnt lgkmcnt(0)
    v_and_b32 v67, 2047, v67
    ds_write_b64 v67, v[48:49] offset:52800
L_pl_71:
    s_mov_b64 exec, s[52:53]
    v_cmp_gt_u32 vcc, 0x200000, v29
    v_and_b32 v29, 0xffff, v29
    s_andn2_b64 s[44:45], exec, vcc
    s_mov_b64 exec, vcc
    ds_write_b64 v29, v[26:27]
    s_cbranch_scc0 L_pl_73
    s_mov_b64 exec, s[44:45]
    v_mov_b32 v67, 0
    v_mov_b32 v71, 8
    ds_add_rtn_u32 v67, v67, v71 offset:52776
    s_waitcnt lgkmcnt(0)
    v_and_b32 v67, 2047, v67
    ds_write_b64 v67, v[26:27] offset:52800
L_pl_73:
    s_mov_b64 exec, -1
L_sc_66:
    v_lshl_or_b32 v9, v32, 5, 16
    s_nop 1
    v_and_b32_dpp v7, v9, v6 quad_perm:[0,0,2,2] row_mask:0xf bank_mask:0xf
    v_and_b32_dpp v8, v9, v6 quad_perm:[1,1,3,3] row_mask:0xf bank_mask:0xf
    s_waitcnt vmcnt(0)
    ds_read_b64_tr_b16 v[22:23], v3 offset:0
    ds_read_b64_tr_b16 v[24:25], v4 offset:0
    ds_read_b64_tr_b16 v[26:27], v3 offset:1024
    ds_read_b64_tr_b16 v[28:29], v4 offset:1024
    s_mov_b32 m0, s38
    s_waitcnt lgkmcnt(0)
    buffer_load_dwordx4 v7, s[16:19], 0 offen lds
    s_add_u32 m0, s38, 1024
    s_nop 0
    buffer_load_dwordx4 v8, s[16:19], 0 offen lds
    v_mfma_f32_16x16x32_bf16 v[72:75], v[22:25], v[14:17], v[72:75]
    v_mfma_f32_16x16x32_bf16 v[76:79], v[26:29], v[18:21], v[76:79]
    v_and_b32_sdwa v9, s40, v32 dst_sel:DWORD dst_unused:UNUSED_PAD src0_sel:DWORD src1_sel:BYTE_2
    v_add_u32 v9, v9, v1
    ds_write_b16 v9, v33
    ds_read_b128 v[14:17], v2
    ds_read_b128 v[18:21], v2 offset:1024
    ds_write_b16 v9, v5
    s_or_b64 s[44:45], s[54:55], s[56:57]
    s_or_b64 s[44:45], s[44:45], s[58:59]
    s_or_b64 s[44:45], s[44:45], s[60:61]
    s_cbranch_scc0 L_sc_75
    s_mov_b64 exec, s[54:55]
    v_lshlrev_b32_sdwa v24, 2, v52 dst_sel:DWORD dst_unused:UNUSED_PAD src0_sel:DWORD src1_sel:BYTE_3
    ds_add_rtn_u32 v24, v24, v55 offset:51744
    s_mov_b64 exec, s[56:57]
    v_lshlrev_b32_sdwa v25, 2, v54 dst_sel:DWORD dst_unused:UNUSED_PAD src0_sel:DWORD src1_sel:BYTE_3
    ds_add_rtn_u32 v25, v25, v55 offset:51744
    v_mov_b32 v22, v54
    v_lshrrev_b32 v23, 16, v53
    s_mov_b64 exec, s[58:59]
    v_lshlrev_b32_sdwa v28, 2, v56 dst_sel:DWORD dst_unused:UNUSED_PAD src0_sel:DWORD src1_sel:BYTE_3
    ds_add_rtn_u32 v28, v28, v55 offset:51744
    s_mov_b64 exec, s[60:61]
    v_lshlrev_b32_sdwa v29, 2, v58 dst_sel:DWORD dst_unused:UNUSED_PAD src0_sel:DWORD src1_sel:BYTE_3
    ds_add_rtn_u32 v29, v29, v55 offset:51744
    v_mov_b32 v26, v58
    v_lshrrev_b32 v27, 16, v57
    s_mov_b64 exec, s[54:55]
    s_waitcnt lgkmcnt(0)
    v_cmp_gt_u32 vcc, 0x200000, v24
    v_and_b32 v24, 0xffff, v24
    s_andn2_b64 s[44:45], exec, vcc
    s_mov_b64 exec, vcc
    ds_write_b64 v24, v[52:53]
    s_cbranch_scc0 L_pl_76
    s_mov_b64 exec, s[44:45]
    v_mov_b32 v67, 0
    v_mov_b32 v71, 8
    ds_add_rtn_u32 v67, v67, v71 offset:52776
    s_waitcnt lgkmcnt(0)
    v_and_b32 v67, 2047, v67
    ds_write_b64 v67, v[52:53] offset:52800
L_pl_76:
    s_mov_b64 exec, s[56:57]
    v_cmp_gt_u32 vcc, 0x200000, v25
    v_and_b32 v25, 0xffff, v25
    s_andn2_b64 s[44:45], exec, vcc
    s_mov_b64 exec, vcc
    ds_write_b64 v25, v[22:23]
    s_cbranch_scc0 L_pl_78
    s_mov_b64 exec, s[44:45]
    v_mov_b32 v67, 0
    v_mov_b32 v71, 8
    ds_add_rtn_u32 v67, v67, v71 offset:52776
    s_waitcnt lgkmcnt(0)
    v_and_b32 v67, 2047, v67
    ds_write_b64 v67, v[22:23] offset:52800
L_pl_78:
    s_mov_b64 exec, s[58:59]
    v_cmp_gt_u32 vcc, 0x200000, v28
    v_and_b32 v28, 0xffff, v28
    s_andn2_b64 s[44:45], exec, vcc
    s_mov_b64 exec, vcc
    ds_write_b64 v28, v[56:57]
    s_cbranch_scc0 L_pl_80
    s_mov_b64 exec, s[44:45]
    v_mov_b32 v67, 0
    v_mov_b32 v71, 8
    ds_add_rtn_u32 v67, v67, v71 offset:52776
    s_waitcnt lgkmcnt(0)
    v_and_b32 v67, 2047, v67
    ds_write_b64 v67, v[56:57] offset:52800
L_pl_80:
    s_mov_b64 exec, s[60:61]
    v_cmp_gt_u32 vcc, 0x200000, v29
    v_and_b32 v29, 0xffff, v29
    s_andn2_b64 s[44:45], exec, vcc
    s_mov_b64 exec, vcc
    ds_write_b64 v29, v[26:27]
    s_cbranch_scc0 L_pl_82
    s_mov_b64 exec, s[44:45]
    v_mov_b32 v67, 0
    v_mov_b32 v71, 8
    ds_add_rtn_u32 v67, v67, v71 offset:52776
    s_waitcnt lgkmcnt(0)
    v_and_b32 v67, 2047, v67
    ds_write_b64 v67, v[26:27] offset:52800
L_pl_82:
    s_mov_b64 exec, -1
L_sc_75:
    v_lshl_or_b32 v9, v34, 5, 16
    s_nop 1
    v_and_b32_dpp v7, v9, v6 quad_perm:[0,0,2,2] row_mask:0xf bank_mask:0xf
    v_and_b32_dpp v8, v9, v6 quad_perm:[1,1,3,3] row_mask:0xf bank_mask:0xf
    s_waitcnt vmcnt(0)
    ds_read_b64_tr_b16 v[22:23], v3 offset:0
    ds_read_b64_tr_b16 v[24:25], v4 offset:0
    ds_read_b64_tr_b16 v[26:27], v3 offset:1024
    ds_read_b64_tr_b16 v[28:29], v4 offset:1024
    s_mov_b32 m0, s38
    s_waitcnt lgkmcnt(0)
    buffer_load_dwordx4 v7, s[16:19], 0 offen lds
    s_add_u32 m0, s38, 1024
    s_nop 0
    buffer_load_dwordx4 v8, s[16:19], 0 offen lds
    v_mfma_f32_16x16x32_bf16 v[80:83], v[22:25], v[14:17], v[80:83]
    v_mfma_f32_16x16x32_bf16 v[84:87], v[26:29], v[18:21], v[84:87]
    v_and_b32_sdwa v9, s40, v34 dst_sel:DWORD dst_unused:UNUSED_PAD src0_sel:DWORD src1_sel:BYTE_2
    v_add_u32 v9, v9, v1
    ds_write_b16 v9, v35
    ds_read_b128 v[14:17], v2
    ds_read_b128 v[18:21], v2 offset:1024
    ds_write_b16 v9, v5
    s_or_b64 s[44:45], s[62:63], s[64:65]
    s_cbranch_scc0 L_sc_84
    s_mov_b64 exec, s[62:63]
    v_lshlrev_b32_sdwa v24, 2, v60 dst_sel:DWORD dst_unused:UNUSED_PAD src0_sel:DWORD src1_sel:BYTE_3
    ds_add_rtn_u32 v24, v24, v55 offset:51744
    s_mov_b64 exec, s[64:65]
    v_lshlrev_b32_sdwa v25, 2, v62 dst_sel:DWORD dst_unused:UNUSED_PAD src0_sel:DWORD src1_sel:BYTE_3
    ds_add_rtn_u32 v25, v25, v55 offset:51744
    v_mov_b32 v22, v62
    v_lshrrev_b32 v23, 16, v61
    s_mov_b64 exec, s[62:63]
    s_waitcnt lgkmcnt(0)
    v_cmp_gt_u32 vcc, 0x200000, v24
    v_and_b32 v24, 0xffff, v24
    s_andn2_b64 s[44:45], exec, vcc
    s_mov_b64 exec, vcc
    ds_write_b64 v24, v[60:61]
    s_cbranch_scc0 L_pl_85
    s_mov_b64 exec, s[44:45]
    v_mov_b32 v67, 0
    v_mov_b32 v71, 8
    ds_add_rtn_u32 v67, v67, v71 offset:52776
    s_waitcnt lgkmcnt(0)
    v_and_b32 v67, 2047, v67
    ds_write_b64 v67, v[60:61] offset:52800
L_pl_85:
    s_mov_b64 exec, s[64:65]
    v_cmp_gt_u32 vcc, 0x200000, v25
    v_and_b32 v25, 0xffff, v25
    s_andn2_b64 s[44:45], exec, vcc
    s_mov_b64 exec, vcc
    ds_write_b64 v25, v[22:23]
    s_cbranch_scc0 L_pl_87
    s_mov_b64 exec, s[44:45]
    v_mov_b32 v67, 0
    v_mov_b32 v71, 8
    ds_add_rtn_u32 v67, v67, v71 offset:52776
    s_waitcnt lgkmcnt(0)
    v_and_b32 v67, 2047, v67
    ds_write_b64 v67, v[22:23] offset:52800
L_pl_87:
    s_mov_b64 exec, -1
L_sc_84:
    s_mov_b32 s31, s32
    s_add_u32 s32, s31, 384
    s_min_u32 s32, s32, s82
    s_add_u32 s88, s88, 149600
    s_mov_b32 s82, s83
    s_mov_b32 s83, s84
    s_mov_b32 s84, s85
    s_mov_b32 s85, s86
    s_mov_b32 s86, s87
    s_cmp_ge_u32 s31, s33
    s_cbranch_scc1 L_fl_89
    v_mov_b32 v67, 0
    v_mov_b32 v71, s30
    ds_write_b32 v67, v71 offset:52768
L_fl_89:
    s_add_u32 s36, s31, 0
    v_add_u32 v22, s36, v0
    v_lshrrev_b32 v23, 5, v22
    v_lshl_add_u32 v23, v23, 3, s42
    ds_read_b64 v[44:45], v23 offset:0
    ds_read_b64 v[48:49], v23 offset:16
    v_not_b32 v24, v22
    v_mul_u32_u24 v25, 12, v22
    s_sub_i32 s35, s32, 0
    v_cmp_gt_i32 s[46:47], s35, v22
    s_waitcnt lgkmcnt(1)
    v_lshlrev_b32 v44, v24, v44
    v_bcnt_u32_b32 v44, v44, v45
    v_lshlrev_b32 v44, 2, v44
    ds_read_b32 v44, v44
    s_sub_i32 s35, s32, 64
    v_cmp_gt_i32 s[50:51], s35, v22
    s_waitcnt lgkmcnt(1)
    v_lshlrev_b32 v48, v24, v48
    v_bcnt_u32_b32 v48, v48, v49
    v_lshlrev_b32 v48, 2, v48
    ds_read_b32 v48, v48
    s_waitcnt lgkmcnt(1)
    v_add_u32 v44, v44, v25
    v_cndmask_b32 v44, -16, v44, s[46:47]
    buffer_load_dwordx3 v[44:46], v44, s[8:11], 0 offen offset:0
    s_waitcnt lgkmcnt(0)
    v_add_u32 v48, v48, v25
    v_cndmask_b32 v48, -16, v48, s[50:51]
    buffer_load_dwordx3 v[48:50], v48, s[8:11], 0 offen offset:768
    v_lshl_or_b32 v9, v36, 5, 16
    s_nop 1
    v_and_b32_dpp v7, v9, v6 quad_perm:[0,0,2,2] row_mask:0xf bank_mask:0xf
    v_and_b32_dpp v8, v9, v6 quad_perm:[1,1,3,3] row_mask:0xf bank_mask:0xf
    s_barrier
    s_waitcnt vmcnt(2)
    ds_read_b64_tr_b16 v[22:23], v3 offset:0
    ds_read_b64_tr_b16 v[24:25], v4 offset:0
    ds_read_b64_tr_b16 v[26:27], v3 offset:1024
    ds_read_b64_tr_b16 v[28:29], v4 offset:1024
    s_mov_b32 m0, s38
    s_waitcnt lgkmcnt(0)
    buffer_load_dwordx4 v7, s[16:19], 0 offen lds
    s_add_u32 m0, s38, 1024
    s_nop 0
    buffer_load_dwordx4 v8, s[16:19], 0 offen lds
    v_mfma_f32_16x16x32_bf16 v[88:91], v[22:25], v[14:17], v[88:91]
    v_mfma_f32_16x16x32_bf16 v[92:95], v[26:29], v[18:21], v[92:95]
    v_and_b32_sdwa v9, s40, v36 dst_sel:DWORD dst_unused:UNUSED_PAD src0_sel:DWORD src1_sel:BYTE_2
    v_add_u32 v9, v9, v1
    ds_write_b16 v9, v37
    ds_read_b128 v[14:17], v2
    ds_read_b128 v[18:21], v2 offset:1024
    ds_write_b16 v9, v5
    s_or_b64 s[44:45], s[66:67], s[68:69]
    s_cbranch_scc0 L_sc_90
    s_mov_b64 exec, s[66:67]
    v_lshlrev_b32_sdwa v24, 2, v64 dst_sel:DWORD dst_unused:UNUSED_PAD src0_sel:DWORD src1_sel:BYTE_3
    ds_add_rtn_u32 v24, v24, v55 offset:51744
    s_mov_b64 exec, s[68:69]
    v_lshlrev_b32_sdwa v25, 2, v66 dst_sel:DWORD dst_unused:UNUSED_PAD src0_sel:DWORD src1_sel:BYTE_3
    ds_add_rtn_u32 v25, v25, v55 offset:51744
    v_mov_b32 v22, v66
    v_lshrrev_b32 v23, 16, v65
    s_mov_b64 exec, s[66:67]
    s_waitcnt lgkmcnt(0)
    v_cmp_gt_u32 vcc, 0x200000, v24
    v_and_b32 v24, 0xffff, v24
    s_andn2_b64 s[44:45], exec, vcc
    s_mov_b64 exec, vcc
    ds_write_b64 v24, v[64:65]
    s_cbranch_scc0 L_pl_91
    s_mov_b64 exec, s[44:45]
    v_mov_b32 v67, 0
    v_mov_b32 v71, 8
    ds_add_rtn_u32 v67, v67, v71 offset:52776
    s_waitcnt lgkmcnt(0)
    v_and_b32 v67, 2047, v67
    ds_write_b64 v67, v[64:65] offset:52800
L_pl_91:
    s_mov_b64 exec, s[68:69]
    v_cmp_gt_u32 vcc, 0x200000, v25
    v_and_b32 v25, 0xffff, v25
    s_andn2_b64 s[44:45], exec, vcc
    s_mov_b64 exec, vcc
    ds_write_b64 v25, v[22:23]
    s_cbranch_scc0 L_pl_93
    s_mov_b64 exec, s[44:45]
    v_mov_b32 v67, 0
    v_mov_b32 v71, 8
    ds_add_rtn_u32 v67, v67, v71 offset:52776
    s_waitcnt lgkmcnt(0)
    v_and_b32 v67, 2047, v67
    ds_write_b64 v67, v[22:23] offset:52800
L_pl_93:
    s_mov_b64 exec, -1
L_sc_90:
    s_add_u32 s36, s31, 128
    v_add_u32 v22, s36, v0
    v_lshrrev_b32 v23, 5, v22
    v_lshl_add_u32 v23, v23, 3, s42
    ds_read_b64 v[52:53], v23 offset:0
    ds_read_b64 v[56:57], v23 offset:16
    v_not_b32 v24, v22
    v_mul_u32_u24 v25, 12, v22
    s_sub_i32 s35, s32, 0
    v_cmp_gt_i32 s[54:55], s35, v22
    s_waitcnt lgkmcnt(1)
    v_lshlrev_b32 v52, v24, v52
    v_bcnt_u32_b32 v52, v52, v53
    v_lshlrev_b32 v52, 2, v52
    ds_read_b32 v52, v52
    s_sub_i32 s35, s32, 64
    v_cmp_gt_i32 s[58:59], s35, v22
    s_waitcnt lgkmcnt(1)
    v_lshlrev_b32 v56, v24, v56
    v_bcnt_u32_b32 v56, v56, v57
    v_lshlrev_b32 v56, 2, v56
    ds_read_b32 v56, v56
    s_waitcnt lgkmcnt(1)
    v_add_u32 v52, v52, v25
    v_cndmask_b32 v52, -16, v52, s[54:55]
    buffer_load_dwordx3 v[52:54], v52, s[8:11], 0 offen offset:0
    s_waitcnt lgkmcnt(0)
    v_add_u32 v56, v56, v25
    v_cndmask_b32 v56, -16, v56, s[58:59]
    buffer_load_dwordx3 v[56:58], v56, s[8:11], 0 offen offset:768
    v_lshl_or_b32 v9, v38, 5, 16
    s_nop 1
    v_and_b32_dpp v7, v9, v6 quad_perm:[0,0,2,2] row_mask:0xf bank_mask:0xf
    v_and_b32_dpp v8, v9, v6 quad_perm:[1,1,3,3] row_mask:0xf bank_mask:0xf
    s_barrier
    s_waitcnt vmcnt(2)
    ds_read_b64_tr_b16 v[22:23], v3 offset:0
    ds_read_b64_tr_b16 v[24:25], v4 offset:0
    ds_read_b64_tr_b16 v[26:27], v3 offset:1024
    ds_read_b64_tr_b16 v[28:29], v4 offset:1024
    s_mov_b32 m0, s38
    s_waitcnt lgkmcnt(0)
    buffer_load_dwordx4 v7, s[16:19], 0 offen lds
    s_add_u32 m0, s38, 1024
    s_nop 0
    buffer_load_dwordx4 v8, s[16:19], 0 offen lds
    v_mfma_f32_16x16x32_bf16 v[96:99], v[22:25], v[14:17], v[96:99]
    v_mfma_f32_16x16x32_bf16 v[100:103], v[26:29], v[18:21], v[100:103]
    v_and_b32_sdwa v9, s40, v38 dst_sel:DWORD dst_unused:UNUSED_PAD src0_sel:DWORD src1_sel:BYTE_2
    v_add_u32 v9, v9, v1
    ds_write_b16 v9, v39
    ds_read_b128 v[14:17], v2
    ds_read_b128 v[18:21], v2 offset:1024
    ds_write_b16 v9, v5
    s_add_u32 s36, s31, 256
    v_add_u32 v22, s36, v0
    v_lshrrev_b32 v23, 5, v22
    v_lshl_add_u32 v23, v23, 3, s42
    ds_read_b64 v[60:61], v23 offset:0
    ds_read_b64 v[64:65], v23 offset:16
    v_not_b32 v24, v22
    v_mul_u32_u24 v25, 12, v22
    s_sub_i32 s35, s32, 0
    v_cmp_gt_i32 s[62:63], s35, v22
    s_waitcnt lgkmcnt(1)
    v_lshlrev_b32 v60, v24, v60
    v_bcnt_u32_b32 v60, v60, v61
    v_lshlrev_b32 v60, 2, v60
    ds_read_b32 v60, v60
    s_sub_i32 s35, s32, 64
    v_cmp_gt_i32 s[66:67], s35, v22
    s_waitcnt lgkmcnt(1)
    v_lshlrev_b32 v64, v24, v64
    v_bcnt_u32_b32 v64, v64, v65
    v_lshlrev_b32 v64, 2, v64
    ds_read_b32 v64, v64
    s_waitcnt lgkmcnt(1)
    v_add_u32 v60, v60, v25
    v_cndmask_b32 v60, -16, v60, s[62:63]
    buffer_load_dwordx3 v[60:62], v60, s[8:11], 0 offen offset:0
    s_waitcnt lgkmcnt(0)
    v_add_u32 v64, v64, v25
    v_cndmask_b32 v64, -16, v64, s[66:67]
    buffer_load_dwordx3 v[64:66], v64, s[8:11], 0 offen offset:768
    v_lshl_or_b32 v9, v40, 5, 16
    s_nop 1
    v_and_b32_dpp v7, v9, v6 quad_perm:[0,0,2,2] row_mask:0xf bank_mask:0xf
    v_and_b32_dpp v8, v9, v6 quad_perm:[1,1,3,3] row_mask:0xf bank_mask:0xf
    s_waitcnt lgkmcnt(0)
    s_barrier
    s_waitcnt vmcnt(2)
    ds_read_b64_tr_b16 v[22:23], v3 offset:0
    ds_read_b64_tr_b16 v[24:25], v4 offset:0
    ds_read_b64_tr_b16 v[26:27], v3 offset:1024
    ds_read_b64_tr_b16 v[28:29], v4 offset:1024
    s_mov_b32 m0, s38
    s_waitcnt lgkmcnt(0)
    buffer_load_dwordx4 v7, s[16:19], 0 offen lds
    s_add_u32 m0, s38, 1024
    s_nop 0
    buffer_load_dwordx4 v8, s[16:19], 0 offen lds
    v_mfma_f32_16x16x32_bf16 v[104:107], v[22:25], v[14:17], v[104:107]
    v_mfma_f32_16x16x32_bf16 v[108:111], v[26:29], v[18:21], v[108:111]
    v_and_b32_sdwa v9, s40, v40 dst_sel:DWORD dst_unused:UNUSED_PAD src0_sel:DWORD src1_sel:BYTE_2
    v_add_u32 v9, v9, v1
    ds_write_b16 v9, v41
    ds_read_b128 v[14:17], v2
    ds_read_b128 v[18:21], v2 offset:1024
    ds_write_b16 v9, v5
    ds_read_b32 v22, v51 offset:52416
    ds_read_b64 v[30:31], v47 offset:44352
    ds_read_b32 v23, v51 offset:52304
    ds_read_b64 v[32:33], v47 offset:36960
    ds_read_b32 v24, v51 offset:52192
    ds_read_b64 v[34:35], v47 offset:29568
    ds_read_b32 v25, v51 offset:52080
    ds_read_b64 v[36:37], v47 offset:22176
    ds_read_b32 v26, v51 offset:51968
    ds_read_b64 v[38:39], v47 offset:14784
    ds_read_b32 v27, v51 offset:51856
    ds_read_b64 v[40:41], v47 offset:7392
    s_mov_b32 s43, 1
    s_waitcnt lgkmcnt(10)
    v_cmp_ge_u32 vcc, v22, v5
    s_cmp_lg_u64 vcc, 0
    s_addc_u32 s43, s43, s43
    v_cndmask_b32 v30, -1, v30, vcc
    v_cndmask_b32 v31, 0, v31, vcc
    s_waitcnt lgkmcnt(8)
    v_cmp_ge_u32 vcc, v23, v5
    s_cmp_lg_u64 vcc, 0
    s_addc_u32 s43, s43, s43
    v_cndmask_b32 v32, -1, v32, vcc
    v_cndmask_b32 v33, 0, v33, vcc
    s_waitcnt lgkmcnt(6)
    v_cmp_ge_u32 vcc, v24, v5
    s_cmp_lg_u64 vcc, 0
    s_addc_u32 s43, s43, s43
    v_cndmask_b32 v34, -1, v34, vcc
    v_cndmask_b32 v35, 0, v35, vcc
    s_waitcnt lgkmcnt(4)
    v_cmp_ge_u32 vcc, v25, v5
    s_cmp_lg_u64 vcc, 0
    s_addc_u32 s43, s43, s43
    v_cndmask_b32 v36, -1, v36, vcc
    v_cndmask_b32 v37, 0, v37, vcc
    s_waitcnt lgkmcnt(2)
    v_cmp_ge_u32 vcc, v26, v5
    s_cmp_lg_u64 vcc, 0
    s_addc_u32 s43, s43, s43
    v_cndmask_b32 v38, -1, v38, vcc
    v_cndmask_b32 v39, 0, v39, vcc
    s_waitcnt lgkmcnt(0)
    v_cmp_ge_u32 vcc, v27, v5
    s_cmp_lg_u64 vcc, 0
    s_addc_u32 s43, s43, s43
    v_cndmask_b32 v40, -1, v40, vcc
    v_cndmask_b32 v41, 0, v41, vcc
    v_lshl_or_b32 v9, v42, 5, 16
    s_nop 1
    v_and_b32_dpp v7, v9, v6 quad_perm:[0,0,2,2] row_mask:0xf bank_mask:0xf
    v_and_b32_dpp v8, v9, v6 quad_perm:[1,1,3,3] row_mask:0xf bank_mask:0xf
    s_waitcnt vmcnt(0)
    ds_read_b64_tr_b16 v[22:23], v3 offset:0
    ds_read_b64_tr_b16 v[24:25], v4 offset:0
    ds_read_b64_tr_b16 v[26:27], v3 offset:1024
    ds_read_b64_tr_b16 v[28:29], v4 offset:1024
    s_mov_b32 m0, s38
    s_waitcnt lgkmcnt(0)
    buffer_load_dwordx4 v7, s[16:19], 0 offen lds
    s_add_u32 m0, s38, 1024
    s_nop 0
    buffer_load_dwordx4 v8, s[16:19], 0 offen lds
    v_mfma_f32_16x16x32_bf16 v[112:115], v[22:25], v[14:17], v[112:115]
    v_mfma_f32_16x16x32_bf16 v[116:119], v[26:29], v[18:21], v[116:119]
    v_and_b32_sdwa v9, s40, v42 dst_sel:DWORD dst_unused:UNUSED_PAD src0_sel:DWORD src1_sel:BYTE_2
    v_add_u32 v9, v9, v1
    ds_write_b16 v9, v43
    ds_read_b128 v[14:17], v2
    ds_read_b128 v[18:21], v2 offset:1024
    ds_write_b16 v9, v5
    s_lshl_b32 s37, s28, 9
    s_add_u32 s35, s37, s41
    v_mov_b32 v67, 0
    v_lshl_add_u32 v71, v0, 3, s35
    v_and_b32 v71, 2047, v71
    ds_read_b96 v[22:24], v67 offset:52768
    ds_read_b64 v[12:13], v71 offset:52800
    ds_read_b32 v28, v51 offset:51744
    ds_read_b64 v[42:43], v47 offset:0
    s_mov_b64 exec, 0x3fff
    ds_write_b32 v59, v63 offset:51744
    s_mov_b64 exec, -1
    s_waitcnt lgkmcnt(1)
    v_cmp_ge_u32 vcc, v28, v5
    s_cmp_lg_u64 vcc, 0
    s_addc_u32 s43, s43, s43
    v_cndmask_b32 v42, -1, v42, vcc
    v_cndmask_b32 v43, 0, v43, vcc
    s_branch L_k2_tail
L_k2_tail:
    v_readfirstlane_b32 s35, v22
    v_readfirstlane_b32 s36, v23
    v_readfirstlane_b32 s34, v24
    v_lshl_or_b32 v9, v30, 5, 16
    s_nop 1
    v_and_b32_dpp v7, v9, v6 quad_perm:[0,0,2,2] row_mask:0xf bank_mask:0xf
    v_and_b32_dpp v8, v9, v6 quad_perm:[1,1,3,3] row_mask:0xf bank_mask:0xf
    s_cmp_lg_u32 s36, 0
    s_cbranch_scc1 L_k2_slow
    s_sub_u32 s36, s34, s41
    s_mov_b32 s41, s34
    s_cmp_gt_u32 s36, 2048
    s_cbranch_scc1 L_k2_slow
    s_sub_i32 s34, s36, s37
    s_ashr_i32 s34, s34, 3
    s_cmp_eq_u32 s35, s30
    s_cselect_b32 s36, 0x10000, s36
    s_add_u32 s30, s30, 1
    s_cmp_le_u32 s36, 256
    s_waitcnt lgkmcnt(0)
    s_barrier
    s_cbranch_scc1 L_k2_last
    s_bitcmp1_b32 s30, 0
    s_cbranch_scc1 L_k2_loopA0
    s_branch L_k2_loopB0
L_k2_slow:
    s_waitcnt vmcnt(0)
    s_mov_b32 s46, 0
    s_add_u32 s14, s14, 64
L_k2_sl_half:
    s_mul_i32 s35, s28, 7168
    v_lshl_add_u32 v30, v0, 4, s35
    v_mov_b32 v22, 0
    v_mov_b32 v23, 0
    v_mov_b32 v24, 0
    v_mov_b32 v25, 0
    s_waitcnt lgkmcnt(0)
    s_barrier
    ds_write_b128 v30, v[22:25] offset:0
    ds_write_b128 v30, v[22:25] offset:1024
    ds_write_b128 v30, v[22:25] offset:2048
    ds_write_b128 v30, v[22:25] offset:3072
    ds_write_b128 v30, v[22:25] offset:4096
    ds_write_b128 v30, v[22:25] offset:5120
    ds_write_b128 v30, v[22:25] offset:6144
    s_waitcnt lgkmcnt(0)
    s_barrier
    s_mov_b32 s49, s28
L_k2_sl_tile:
    s_mov_b32 s48, 0
L_k2_sl_g:
    s_mul_i32 s35, s49, 3072
    s_mul_i32 s36, s29, 12
    s_add_u32 s35, s35, s36
    s_lshl_b32 s36, s48, 1
    s_add_u32 s35, s35, s36
    s_movk_i32 s36, -12
    s_cmp_eq_u32 s29, 0
    s_cselect_b32 s36, 3058, s36
    s_add_u32 s36, s36, s35
    s_or_b32 s37, s29, s48
    s_cselect_b32 s36, s36, 0x40000000
    v_mov_b32 v30, s35
    v_mov_b32 v31, s36
    buffer_load_ushort v30, v30, s[12:15], 0 offen
    buffer_load_ushort v31, v31, s[12:15], 0 offen
    s_waitcnt vmcnt(0)
    v_readfirstlane_b32 s51, v30
    v_readfirstlane_b32 s50, v31
    s_mul_i32 s47, s49, 157696
    s_add_u32 s47, s47, 4096
L_k2_sl_n:
    s_cmp_ge_u32 s50, s51
    s_cbranch_scc1 L_k2_sl_next
    v_add_u32 v30, s50, v0
    v_cmp_gt_u32 s[44:45], s51, v30
    v_mad_u32_u24 v30, v30, 6, s47
    v_and_b32 v31, 2, v30
    v_and_b32 v30, -4, v30
    v_cmp_ne_u32 vcc, 0, v31
    v_cndmask_b32 v30, -16, v30, s[44:45]
    buffer_load_dwordx2 v[44:45], v30, s[8:11], 0 offen
    s_mul_i32 s35, s46, 1568
    s_waitcnt vmcnt(0)
    v_lshlrev_b32 v13, 16, v45
    v_cndmask_b32 v12, v44, v45, vcc
    v_cndmask_b32 v13, v13, v44, vcc
    v_and_b32 v13, 0xffff0000, v13
    v_lshrrev_b32 v31, 20, v12
    v_subrev_u32 v31, s35, v31
    v_cmp_gt_u32 vcc, 1568, v31
    v_and_b32 v30, 0xfffff, v12
    v_lshlrev_b32 v31, 6, v31
    v_lshlrev_b32 v30, 5, v30
    s_and_b64 exec, vcc, s[44:45]
    s_cbranch_scc0 L_k2_sl_skip
    buffer_load_dwordx4 v[22:25], v30, s[16:19], 0 offen
    buffer_load_dwordx4 v[26:29], v30, s[16:19], 0 offen offset:16
    s_waitcnt vmcnt(0)
    v_lshlrev_b32 v32, 16, v22
    v_and_b32 v33, 0xffff0000, v22
    v_mul_f32 v32, v32, v13
    v_mul_f32 v33, v33, v13
    ds_add_f32 v31, v32 offset:0
    ds_add_f32 v31, v33 offset:4
    v_lshlrev_b32 v32, 16, v23
    v_and_b32 v33, 0xffff0000, v23
    v_mul_f32 v32, v32, v13
    v_mul_f32 v33, v33, v13
    ds_add_f32 v31, v32 offset:8
    ds_add_f32 v31, v33 offset:12
    v_lshlrev_b32 v32, 16, v24
    v_and_b32 v33, 0xffff0000, v24
    v_mul_f32 v32, v32, v13
    v_mul_f32 v33, v33, v13
    ds_add_f32 v31, v32 offset:16
    ds_add_f32 v31, v33 offset:20
    v_lshlrev_b32 v32, 16, v25
    v_and_b32 v33, 0xffff0000, v25
    v_mul_f32 v32, v32, v13
    v_mul_f32 v33, v33, v13
    ds_add_f32 v31, v32 offset:24
    ds_add_f32 v31, v33 offset:28
    v_lshlrev_b32 v32, 16, v26
    v_and_b32 v33, 0xffff0000, v26
    v_mul_f32 v32, v32, v13
    v_mul_f32 v33, v33, v13
    ds_add_f32 v31, v32 offset:32
    ds_add_f32 v31, v33 offset:36
    v_lshlrev_b32 v32, 16, v27
    v_and_b32 v33, 0xffff0000, v27
    v_mul_f32 v32, v32, v13
    v_mul_f32 v33, v33, v13
    ds_add_f32 v31, v32 offset:40
    ds_add_f32 v31, v33 offset:44
    v_lshlrev_b32 v32, 16, v28
    v_and_b32 v33, 0xffff0000, v28
    v_mul_f32 v32, v32, v13
    v_mul_f32 v33, v33, v13
    ds_add_f32 v31, v32 offset:48
    ds_add_f32 v31, v33 offset:52
    v_lshlrev_b32 v32, 16, v29
    v_and_b32 v33, 0xffff0000, v29
    v_mul_f32 v32, v32, v13
    v_mul_f32 v33, v33, v13
    ds_add_f32 v31, v32 offset:56
    ds_add_f32 v31, v33 offset:60
L_k2_sl_skip:
    s_mov_b64 exec, -1
    s_add_u32 s50, s50, 64
    s_branch L_k2_sl_n
L_k2_sl_next:
    s_add_u32 s48, s48, 1
    s_cmp_lt_u32 s48, 6
    s_cbranch_scc1 L_k2_sl_g
    s_add_u32 s49, s49, 14
    s_cmp_lt_u32 s49, 512
    s_cbranch_scc1 L_k2_sl_tile
    s_waitcnt lgkmcnt(0)
    s_barrier
    s_mul_i32 s35, s46, 49
    s_sub_u32 s35, s28, s35
    v_and_b32 v30, 15, v0
    v_and_b32 v31, 48, v0
    v_lshl_add_u32 v30, v30, 6, v31
    s_add_u32 s36, s35, 84
    s_cmp_ge_u32 s36, 49
    s_cbranch_scc1 L_slr_95
    s_lshl_b32 s36, s36, 11
    v_add_u32 v31, s36, v30
    ds_read_b128 v[72:75], v31
    ds_read_b128 v[76:79], v31 offset:1024
L_slr_95:
    s_add_u32 s36, s35, 70
    s_cmp_ge_u32 s36, 49
    s_cbranch_scc1 L_slr_96
    s_lshl_b32 s36, s36, 11
    v_add_u32 v31, s36, v30
    ds_read_b128 v[80:83], v31
    ds_read_b128 v[84:87], v31 offset:1024
L_slr_96:
    s_add_u32 s36, s35, 56
    s_cmp_ge_u32 s36, 49
    s_cbranch_scc1 L_slr_97
    s_lshl_b32 s36, s36, 11
    v_add_u32 v31, s36, v30
    ds_read_b128 v[88:91], v31
    ds_read_b128 v[92:95], v31 offset:1024
L_slr_97:
    s_add_u32 s36, s35, 42
    s_cmp_ge_u32 s36, 49
    s_cbranch_scc1 L_slr_98
    s_lshl_b32 s36, s36, 11
    v_add_u32 v31, s36, v30
    ds_read_b128 v[96:99], v31
    ds_read_b128 v[100:103], v31 offset:1024
L_slr_98:
    s_add_u32 s36, s35, 28
    s_cmp_ge_u32 s36, 49
    s_cbranch_scc1 L_slr_99
    s_lshl_b32 s36, s36, 11
    v_add_u32 v31, s36, v30
    ds_read_b128 v[104:107], v31
    ds_read_b128 v[108:111], v31 offset:1024
L_slr_99:
    s_add_u32 s36, s35, 14
    s_cmp_ge_u32 s36, 49
    s_cbranch_scc1 L_slr_100
    s_lshl_b32 s36, s36, 11
    v_add_u32 v31, s36, v30
    ds_read_b128 v[112:115], v31
    ds_read_b128 v[116:119], v31 offset:1024
L_slr_100:
    s_add_u32 s36, s35, 0
    s_cmp_ge_u32 s36, 49
    s_cbranch_scc1 L_slr_101
    s_lshl_b32 s36, s36, 11
    v_add_u32 v31, s36, v30
    ds_read_b128 v[120:123], v31
    ds_read_b128 v[124:127], v31 offset:1024
L_slr_101:
    s_add_u32 s46, s46, 1
    s_cmp_lt_u32 s46, 2
    s_cbranch_scc1 L_k2_sl_half
    s_waitcnt lgkmcnt(0)
    s_barrier
    s_mov_b32 s43, 0
    s_branch L_k2_final
L_k2_last:
    s_cmp_gt_u32 s30, 3
    s_cbranch_scc1 L_wl_102
    s_waitcnt vmcnt(0)
    s_barrier
L_wl_102:
    s_cmp_eq_u32 s36, 0
    s_cbranch_scc1 L_k2_final
    s_sub_u32 s35, s41, s36
    v_lshrrev_b32 v67, 1, v0
    v_lshlrev_b32 v67, 3, v67
    v_add_u32 v71, s35, v67
    v_and_b32 v71, 2047, v71
    ds_read_b64 v[12:13], v71 offset:52800
    v_cmp_gt_u32 vcc, s36, v67
    v_lshrrev_b32 v67, 2, v51
    s_mov_b64 s[44:45], 0
    s_waitcnt lgkmcnt(0)
    v_lshrrev_b32 v71, 24, v12
    v_sub_u32 v71, v71, v67
    v_cndmask_b32 v71, -1, v71, vcc
    s_movk_i32 s35, 168
    v_cmp_eq_u32 s[46:47], s35, v71
    s_or_b64 s[44:45], s[44:45], s[46:47]
    s_movk_i32 s35, 140
    v_cmp_eq_u32 s[48:49], s35, v71
    s_or_b64 s[44:45], s[44:45], s[48:49]
    s_movk_i32 s35, 112
    v_cmp_eq_u32 s[50:51], s35, v71
    s_or_b64 s[44:45], s[44:45], s[50:51]
    s_movk_i32 s35, 84
    v_cmp_eq_u32 s[52:53], s35, v71
    s_or_b64 s[44:45], s[44:45], s[52:53]
    s_movk_i32 s35, 56
    v_cmp_eq_u32 s[54:55], s35, v71
    s_or_b64 s[44:45], s[44:45], s[54:55]
    s_movk_i32 s35, 28
    v_cmp_eq_u32 s[56:57], s35, v71
    s_or_b64 s[44:45], s[44:45], s[56:57]
    s_movk_i32 s35, 0
    v_cmp_eq_u32 s[58:59], s35, v71
    s_or_b64 s[44:45], s[44:45], s[58:59]
    s_cbranch_scc0 L_k2_final
    s_waitcnt vmcnt(0)
    ds_read_b64_tr_b16 v[22:23], v3 offset:0
    ds_read_b64_tr_b16 v[24:25], v4 offset:0
    ds_read_b64_tr_b16 v[26:27], v3 offset:1024
    ds_read_b64_tr_b16 v[28:29], v4 offset:1024
    s_mov_b32 m0, s38
    s_waitcnt lgkmcnt(0)
    v_mfma_f32_16x16x32_bf16 v[120:123], v[22:25], v[14:17], v[120:123]
    v_mfma_f32_16x16x32_bf16 v[124:127], v[26:29], v[18:21], v[124:127]
    s_bitset0_b32 s43, 7
    s_cmp_eq_u64 s[46:47], 0
    s_cbranch_scc1 L_mf_103
    s_mov_b32 m0, s38
    v_cndmask_b32 v44, -1, v12, s[46:47]
    v_cndmask_b32 v45, 0, v13, s[46:47]
    v_lshl_or_b32 v9, v44, 5, 16
    s_nop 1
    v_and_b32_dpp v7, v9, v6 quad_perm:[0,0,2,2] row_mask:0xf bank_mask:0xf
    v_and_b32_dpp v8, v9, v6 quad_perm:[1,1,3,3] row_mask:0xf bank_mask:0xf
    buffer_load_dwordx4 v7, s[16:19], 0 offen lds
    s_add_u32 m0, s38, 1024
    s_nop 0
    buffer_load_dwordx4 v8, s[16:19], 0 offen lds
    v_and_b32_sdwa v9, s40, v44 dst_sel:DWORD dst_unused:UNUSED_PAD src0_sel:DWORD src1_sel:BYTE_2
    v_add_u32 v9, v9, v1
    ds_write_b16 v9, v45
    ds_read_b128 v[14:17], v2
    ds_read_b128 v[18:21], v2 offset:1024
    ds_write_b16 v9, v5
    s_waitcnt vmcnt(0)
    ds_read_b64_tr_b16 v[22:23], v3 offset:0
    ds_read_b64_tr_b16 v[24:25], v4 offset:0
    ds_read_b64_tr_b16 v[26:27], v3 offset:1024
    ds_read_b64_tr_b16 v[28:29], v4 offset:1024
    s_mov_b32 m0, s38
    s_waitcnt lgkmcnt(0)
    v_mfma_f32_16x16x32_bf16 v[72:75], v[22:25], v[14:17], v[72:75]
    v_mfma_f32_16x16x32_bf16 v[76:79], v[26:29], v[18:21], v[76:79]
L_mf_103:
    s_cmp_eq_u64 s[48:49], 0
    s_cbranch_scc1 L_mf_104
    s_mov_b32 m0, s38
    v_cndmask_b32 v44, -1, v12, s[48:49]
    v_cndmask_b32 v45, 0, v13, s[48:49]
    v_lshl_or_b32 v9, v44, 5, 16
    s_nop 1
    v_and_b32_dpp v7, v9, v6 quad_perm:[0,0,2,2] row_mask:0xf bank_mask:0xf
    v_and_b32_dpp v8, v9, v6 quad_perm:[1,1,3,3] row_mask:0xf bank_mask:0xf
    buffer_load_dwordx4 v7, s[16:19], 0 offen lds
    s_add_u32 m0, s38, 1024
    s_nop 0
    buffer_load_dwordx4 v8, s[16:19], 0 offen lds
    v_and_b32_sdwa v9, s40, v44 dst_sel:DWORD dst_unused:UNUSED_PAD src0_sel:DWORD src1_sel:BYTE_2
    v_add_u32 v9, v9, v1
    ds_write_b16 v9, v45
    ds_read_b128 v[14:17], v2
    ds_read_b128 v[18:21], v2 offset:1024
    ds_write_b16 v9, v5
    s_waitcnt vmcnt(0)
    ds_read_b64_tr_b16 v[22:23], v3 offset:0
    ds_read_b64_tr_b16 v[24:25], v4 offset:0
    ds_read_b64_tr_b16 v[26:27], v3 offset:1024
    ds_read_b64_tr_b16 v[28:29], v4 offset:1024
    s_mov_b32 m0, s38
    s_waitcnt lgkmcnt(0)
    v_mfma_f32_16x16x32_bf16 v[80:83], v[22:25], v[14:17], v[80:83]
    v_mfma_f32_16x16x32_bf16 v[84:87], v[26:29], v[18:21], v[84:87]
L_mf_104:
    s_cmp_eq_u64 s[50:51], 0
    s_cbranch_scc1 L_mf_105
    s_mov_b32 m0, s38
    v_cndmask_b32 v44, -1, v12, s[50:51]
    v_cndmask_b32 v45, 0, v13, s[50:51]
    v_lshl_or_b32 v9, v44, 5, 16
    s_nop 1
    v_and_b32_dpp v7, v9, v6 quad_perm:[0,0,2,2] row_mask:0xf bank_mask:0xf
    v_and_b32_dpp v8, v9, v6 quad_perm:[1,1,3,3] row_mask:0xf bank_mask:0xf
    buffer_load_dwordx4 v7, s[16:19], 0 offen lds
    s_add_u32 m0, s38, 1024
    s_nop 0
    buffer_load_dwordx4 v8, s[16:19], 0 offen lds
    v_and_b32_sdwa v9, s40, v44 dst_sel:DWORD dst_unused:UNUSED_PAD src0_sel:DWORD src1_sel:BYTE_2
    v_add_u32 v9, v9, v1
    ds_write_b16 v9, v45
    ds_read_b128 v[14:17], v2
    ds_read_b128 v[18:21], v2 offset:1024
    ds_write_b16 v9, v5
    s_waitcnt vmcnt(0)
    ds_read_b64_tr_b16 v[22:23], v3 offset:0
    ds_read_b64_tr_b16 v[24:25], v4 offset:0
    ds_read_b64_tr_b16 v[26:27], v3 offset:1024
    ds_read_b64_tr_b16 v[28:29], v4 offset:1024
    s_mov_b32 m0, s38
    s_waitcnt lgkmcnt(0)
    v_mfma_f32_16x16x32_bf16 v[88:91], v[22:25], v[14:17], v[88:91]
    v_mfma_f32_16x16x32_bf16 v[92:95], v[26:29], v[18:21], v[92:95]
L_mf_105:
    s_cmp_eq_u64 s[52:53], 0
    s_cbranch_scc1 L_mf_106
    s_mov_b32 m0, s38
    v_cndmask_b32 v44, -1, v12, s[52:53]
    v_cndmask_b32 v45, 0, v13, s[52:53]
    v_lshl_or_b32 v9, v44, 5, 16
    s_nop 1
    v_and_b32_dpp v7, v9, v6 quad_perm:[0,0,2,2] row_mask:0xf bank_mask:0xf
    v_and_b32_dpp v8, v9, v6 quad_perm:[1,1,3,3] row_mask:0xf bank_mask:0xf
    buffer_load_dwordx4 v7, s[16:19], 0 offen lds
    s_add_u32 m0, s38, 1024
    s_nop 0
    buffer_load_dwordx4 v8, s[16:19], 0 offen lds
    v_and_b32_sdwa v9, s40, v44 dst_sel:DWORD dst_unused:UNUSED_PAD src0_sel:DWORD src1_sel:BYTE_2
    v_add_u32 v9, v9, v1
    ds_write_b16 v9, v45
    ds_read_b128 v[14:17], v2
    ds_read_b128 v[18:21], v2 offset:1024
    ds_write_b16 v9, v5
    s_waitcnt vmcnt(0)
    ds_read_b64_tr_b16 v[22:23], v3 offset:0
    ds_read_b64_tr_b16 v[24:25], v4 offset:0
    ds_read_b64_tr_b16 v[26:27], v3 offset:1024
    ds_read_b64_tr_b16 v[28:29], v4 offset:1024
    s_mov_b32 m0, s38
    s_waitcnt lgkmcnt(0)
    v_mfma_f32_16x16x32_bf16 v[96:99], v[22:25], v[14:17], v[96:99]
    v_mfma_f32_16x16x32_bf16 v[100:103], v[26:29], v[18:21], v[100:103]
L_mf_106:
    s_cmp_eq_u64 s[54:55], 0
    s_cbranch_scc1 L_mf_107
    s_mov_b32 m0, s38
    v_cndmask_b32 v44, -1, v12, s[54:55]
    v_cndmask_b32 v45, 0, v13, s[54:55]
    v_lshl_or_b32 v9, v44, 5, 16
    s_nop 1
    v_and_b32_dpp v7, v9, v6 quad_perm:[0,0,2,2] row_mask:0xf bank_mask:0xf
    v_and_b32_dpp v8, v9, v6 quad_perm:[1,1,3,3] row_mask:0xf bank_mask:0xf
    buffer_load_dwordx4 v7, s[16:19], 0 offen lds
    s_add_u32 m0, s38, 1024
    s_nop 0
    buffer_load_dwordx4 v8, s[16:19], 0 offen lds
    v_and_b32_sdwa v9, s40, v44 dst_sel:DWORD dst_unused:UNUSED_PAD src0_sel:DWORD src1_sel:BYTE_2
    v_add_u32 v9, v9, v1
    ds_write_b16 v9, v45
    ds_read_b128 v[14:17], v2
    ds_read_b128 v[18:21], v2 offset:1024
    ds_write_b16 v9, v5
    s_waitcnt vmcnt(0)
    ds_read_b64_tr_b16 v[22:23], v3 offset:0
    ds_read_b64_tr_b16 v[24:25], v4 offset:0
    ds_read_b64_tr_b16 v[26:27], v3 offset:1024
    ds_read_b64_tr_b16 v[28:29], v4 offset:1024
    s_mov_b32 m0, s38
    s_waitcnt lgkmcnt(0)
    v_mfma_f32_16x16x32_bf16 v[104:107], v[22:25], v[14:17], v[104:107]
    v_mfma_f32_16x16x32_bf16 v[108:111], v[26:29], v[18:21], v[108:111]
L_mf_107:
    s_cmp_eq_u64 s[56:57], 0
    s_cbranch_scc1 L_mf_108
    s_mov_b32 m0, s38
    v_cndmask_b32 v44, -1, v12, s[56:57]
    v_cndmask_b32 v45, 0, v13, s[56:57]
    v_lshl_or_b32 v9, v44, 5, 16
    s_nop 1
    v_and_b32_dpp v7, v9, v6 quad_perm:[0,0,2,2] row_mask:0xf bank_mask:0xf
    v_and_b32_dpp v8, v9, v6 quad_perm:[1,1,3,3] row_mask:0xf bank_mask:0xf
    buffer_load_dwordx4 v7, s[16:19], 0 offen lds
    s_add_u32 m0, s38, 1024
    s_nop 0
    buffer_load_dwordx4 v8, s[16:19], 0 offen lds
    v_and_b32_sdwa v9, s40, v44 dst_sel:DWORD dst_unused:UNUSED_PAD src0_sel:DWORD src1_sel:BYTE_2
    v_add_u32 v9, v9, v1
    ds_write_b16 v9, v45
    ds_read_b128 v[14:17], v2
    ds_read_b128 v[18:21], v2 offset:1024
    ds_write_b16 v9, v5
    s_waitcnt vmcnt(0)
    ds_read_b64_tr_b16 v[22:23], v3 offset:0
    ds_read_b64_tr_b16 v[24:25], v4 offset:0
    ds_read_b64_tr_b16 v[26:27], v3 offset:1024
    ds_read_b64_tr_b16 v[28:29], v4 offset:1024
    s_mov_b32 m0, s38
    s_waitcnt lgkmcnt(0)
    v_mfma_f32_16x16x32_bf16 v[112:115], v[22:25], v[14:17], v[112:115]
    v_mfma_f32_16x16x32_bf16 v[116:119], v[26:29], v[18:21], v[116:119]
L_mf_108:
    s_cmp_eq_u64 s[58:59], 0
    s_cbranch_scc1 L_mf_109
    s_mov_b32 m0, s38
    v_cndmask_b32 v44, -1, v12, s[58:59]
    v_cndmask_b32 v45, 0, v13, s[58:59]
    v_lshl_or_b32 v9, v44, 5, 16
    s_nop 1
    v_and_b32_dpp v7, v9, v6 quad_perm:[0,0,2,2] row_mask:0xf bank_mask:0xf
    v_and_b32_dpp v8, v9, v6 quad_perm:[1,1,3,3] row_mask:0xf bank_mask:0xf
    buffer_load_dwordx4 v7, s[16:19], 0 offen lds
    s_add_u32 m0, s38, 1024
    s_nop 0
    buffer_load_dwordx4 v8, s[16:19], 0 offen lds
    v_and_b32_sdwa v9, s40, v44 dst_sel:DWORD dst_unused:UNUSED_PAD src0_sel:DWORD src1_sel:BYTE_2
    v_add_u32 v9, v9, v1
    ds_write_b16 v9, v45
    ds_read_b128 v[14:17], v2
    ds_read_b128 v[18:21], v2 offset:1024
    ds_write_b16 v9, v5
    s_waitcnt vmcnt(0)
    ds_read_b64_tr_b16 v[22:23], v3 offset:0
    ds_read_b64_tr_b16 v[24:25], v4 offset:0
    ds_read_b64_tr_b16 v[26:27], v3 offset:1024
    ds_read_b64_tr_b16 v[28:29], v4 offset:1024
    s_mov_b32 m0, s38
    s_waitcnt lgkmcnt(0)
    v_mfma_f32_16x16x32_bf16 v[120:123], v[22:25], v[14:17], v[120:123]
    v_mfma_f32_16x16x32_bf16 v[124:127], v[26:29], v[18:21], v[124:127]
L_mf_109:
L_k2_final:
    s_mov_b64 s[4:5], s[16:17]
    s_mov_b32 s6, 25600000
    s_mov_b32 s7, 0x20000
    s_setprio 3
    s_bitcmp1_b32 s43, 7
    s_cbranch_scc0 L_fa_110
    s_waitcnt vmcnt(0)
    ds_read_b64_tr_b16 v[22:23], v3 offset:0
    ds_read_b64_tr_b16 v[24:25], v4 offset:0
    ds_read_b64_tr_b16 v[26:27], v3 offset:1024
    ds_read_b64_tr_b16 v[28:29], v4 offset:1024
    s_mov_b32 m0, s38
    s_waitcnt lgkmcnt(0)
    v_mfma_f32_16x16x32_bf16 v[120:123], v[22:25], v[14:17], v[120:123]
    v_mfma_f32_16x16x32_bf16 v[124:127], v[26:29], v[18:21], v[124:127]
L_fa_110:
    s_bitcmp1_b32 s43, 6
    s_cbranch_scc0 L_fb_111
    s_mov_b32 m0, s38
    v_lshl_or_b32 v9, v30, 5, 16
    s_nop 1
    v_and_b32_dpp v7, v9, v6 quad_perm:[0,0,2,2] row_mask:0xf bank_mask:0xf
    v_and_b32_dpp v8, v9, v6 quad_perm:[1,1,3,3] row_mask:0xf bank_mask:0xf
    buffer_load_dwordx4 v7, s[16:19], 0 offen lds
    s_add_u32 m0, s38, 1024
    s_nop 0
    buffer_load_dwordx4 v8, s[16:19], 0 offen lds
    v_and_b32_sdwa v9, s40, v30 dst_sel:DWORD dst_unused:UNUSED_PAD src0_sel:DWORD src1_sel:BYTE_2
    v_add_u32 v9, v9, v1
    ds_write_b16 v9, v31
    ds_read_b128 v[14:17], v2
    ds_read_b128 v[18:21], v2 offset:1024
    ds_write_b16 v9, v5
L_fb_111:
    v_and_b32 v70, 15, v0
    v_lshrrev_b32 v9, 4, v0
    v_lshlrev_b32 v13, 1, v70
    s_mov_b32 s35, 132096
    v_lshl_add_u32 v52, v0, 3, s35
    v_and_b32 v54, 7, v0
    v_lshl_add_u32 v54, v54, 3, s35
    v_lshl_add_u32 v54, v9, 6, v54
    v_and_b32 v56, 8, v0
    v_lshl_add_u32 v54, v56, 5, v54
    v_lshl_add_u32 v56, v9, 2, s35
    ds_read_b64_tr_b16 v[44:45], v52
    ds_read_b64_tr_b16 v[46:47], v52 offset:512
    ds_read_b64_tr_b16 v[48:49], v54 offset:1024
    ds_read_b32 v56, v56 offset:1536
    s_mul_i32 s35, s29, 100096
    s_add_u32 s36, s35, 100096
    s_min_u32 s22, s22, s36
    s_lshl_b32 s36, s28, 10
    s_add_u32 s35, s35, s36
    s_mul_i32 s51, s28, 2048
    v_lshlrev_b32 v12, 4, v0
    v_add_u32 v71, s51, v12
    v_add_u32 v12, s35, v12
    s_lshr_b32 s35, s35, 4
    s_mul_i32 s37, s28, 448
    s_add_u32 s37, s37, 28672
    v_lshrrev_b32 v58, 2, v0
    v_and_b32 v59, 3, v0
    v_mul_u32_u24 v58, 896, v58
    v_lshl_add_u32 v58, v59, 4, v58
    v_add_u32 v58, s35, v58
    v_add_u32 v13, s37, v13
    s_mov_b32 m0, s37
    s_mov_b64 exec, 0xfffffff
    buffer_load_dwordx4 v58, s[24:27], 0 offen lds
    s_mov_b64 exec, -1
    s_add_u32 s37, s51, 0
    s_mov_b32 m0, s37
    s_mov_b32 s37, 86016
    buffer_load_dwordx4 v12, s[4:7], s37 offen  lds
    v_lshlrev_b32 v9, 3, v9
    v_lshl_add_u32 v70, v70, 5, v9
    v_add_u32 v70, s51, v70
    s_mov_b32 s46, 0xc1200000
    s_mov_b32 s47, 0xc1200000
    s_mov_b32 s48, 0x3fb8aa3b
    s_mov_b32 s49, 0x3fb8aa3b
    s_mov_b32 s50, 0xffff0000
    s_waitcnt lgkmcnt(0)
    v_mov_b32 v53, 0
    v_mov_b32 v54, 0
    v_mov_b32 v50, v49
    v_mov_b32 v51, v48
    v_and_b32 v57, s50, v56
    v_lshlrev_b32 v56, 16, v56
    s_setprio 3
    s_waitcnt vmcnt(0)
    s_bitcmp1_b32 s43, 6
    s_cbranch_scc0 L_fa_112
    s_waitcnt vmcnt(2)
    ds_read_b64_tr_b16 v[22:23], v3 offset:0
    ds_read_b64_tr_b16 v[24:25], v4 offset:0
    ds_read_b64_tr_b16 v[26:27], v3 offset:1024
    ds_read_b64_tr_b16 v[28:29], v4 offset:1024
    s_mov_b32 m0, s38
    s_waitcnt lgkmcnt(0)
    v_mfma_f32_16x16x32_bf16 v[72:75], v[22:25], v[14:17], v[72:75]
    v_mfma_f32_16x16x32_bf16 v[76:79], v[26:29], v[18:21], v[76:79]
L_fa_112:
    s_bitcmp1_b32 s43, 5
    s_cbranch_scc0 L_fb_113
    s_mov_b32 m0, s38
    v_lshl_or_b32 v9, v32, 5, 16
    s_nop 1
    v_and_b32_dpp v7, v9, v6 quad_perm:[0,0,2,2] row_mask:0xf bank_mask:0xf
    v_and_b32_dpp v8, v9, v6 quad_perm:[1,1,3,3] row_mask:0xf bank_mask:0xf
    buffer_load_dwordx4 v7, s[16:19], 0 offen lds
    s_add_u32 m0, s38, 1024
    s_nop 0
    buffer_load_dwordx4 v8, s[16:19], 0 offen lds
    v_and_b32_sdwa v9, s40, v32 dst_sel:DWORD dst_unused:UNUSED_PAD src0_sel:DWORD src1_sel:BYTE_2
    v_add_u32 v9, v9, v1
    ds_write_b16 v9, v33
    ds_read_b128 v[14:17], v2
    ds_read_b128 v[18:21], v2 offset:1024
    ds_write_b16 v9, v5
L_fb_113:
    s_add_u32 s37, s51, 1024
    s_mov_b32 m0, s37
    s_mov_b32 s37, 71680
    buffer_load_dwordx4 v12, s[4:7], s37 offen  lds
    ds_read_u16 v52, v13 offset:384
    ds_read_u16 v55, v13 offset:416
    ds_read_b64 v[22:23], v70 offset:0
    ds_read_b64 v[26:27], v70 offset:512
    s_waitcnt lgkmcnt(2)
    v_lshlrev_b32 v52, 16, v52
    v_lshlrev_b32 v55, 16, v55
    v_sub_f32 v58, v52, v56
    v_sub_f32 v59, v52, v57
    v_sub_f32 v62, v55, v56
    v_sub_f32 v63, v55, v57
    v_cvt_pk_bf16_f32 v58, 0, v58
    v_cvt_pk_bf16_f32 v59, 0, v59
    v_cvt_pk_bf16_f32 v62, 0, v62
    v_cvt_pk_bf16_f32 v63, 0, v63
    v_pk_mul_f32 v[58:59], v[58:59], v[58:59]
    v_pk_mul_f32 v[62:63], v[62:63], v[62:63]
    v_cvt_pk_bf16_f32 v58, 0, v58
    v_cvt_pk_bf16_f32 v59, 0, v59
    v_cvt_pk_bf16_f32 v62, 0, v62
    v_cvt_pk_bf16_f32 v63, 0, v63
    v_pk_mul_f32 v[58:59], v[58:59], s[46:47]
    v_pk_mul_f32 v[62:63], v[62:63], s[46:47]
    v_cvt_pk_bf16_f32 v58, 0, v58
    v_cvt_pk_bf16_f32 v59, 0, v59
    v_cvt_pk_bf16_f32 v62, 0, v62
    v_cvt_pk_bf16_f32 v63, 0, v63
    v_pk_mul_f32 v[58:59], v[58:59], s[48:49]
    v_pk_mul_f32 v[62:63], v[62:63], s[48:49]
    v_exp_f32 v58, v58
    v_exp_f32 v59, v59
    v_exp_f32 v62, v62
    v_exp_f32 v63, v63
    v_cvt_pk_bf16_f32 v66, v72, v73
    v_cvt_pk_bf16_f32 v67, v74, v75
    v_cvt_pk_bf16_f32 v68, v76, v77
    v_cvt_pk_bf16_f32 v69, v78, v79
    v_cvt_pk_bf16_f32 v52, v58, v59
    v_cvt_pk_bf16_f32 v55, v62, v63
    v_mfma_f32_16x16x16_bf16 v[72:75], v[44:45], v[66:67], 0
    v_mfma_f32_16x16x16_bf16 v[76:79], v[44:45], v[68:69], 0
    v_mfma_f32_16x16x16_bf16 v[58:61], v[48:49], v[52:53], 0
    v_mfma_f32_16x16x16_bf16 v[62:65], v[50:51], v[54:55], 0
    s_waitcnt lgkmcnt(0)
    v_and_b32 v25, s50, v23
    v_lshlrev_b32 v24, 16, v23
    v_and_b32 v23, s50, v22
    v_lshlrev_b32 v22, 16, v22
    v_and_b32 v29, s50, v27
    v_lshlrev_b32 v28, 16, v27
    v_and_b32 v27, s50, v26
    v_lshlrev_b32 v26, 16, v26
    v_pk_mul_f32 v[58:59], v[58:59], v[72:73]
    v_pk_mul_f32 v[60:61], v[60:61], v[74:75]
    v_pk_mul_f32 v[62:63], v[62:63], v[76:77]
    v_pk_mul_f32 v[64:65], v[64:65], v[78:79]
    v_cvt_pk_bf16_f32 v66, v58, v59
    v_cvt_pk_bf16_f32 v67, v60, v61
    v_cvt_pk_bf16_f32 v68, v62, v63
    v_cvt_pk_bf16_f32 v69, v64, v65
    v_mfma_f32_16x16x16_bf16 v[58:61], v[50:51], v[52:53], 0
    v_mfma_f32_16x16x16_bf16 v[62:65], v[48:49], v[54:55], 0
    v_mfma_f32_16x16x16_bf16 v[72:75], v[46:47], v[66:67], 0
    v_mfma_f32_16x16x16_bf16 v[76:79], v[46:47], v[68:69], 0
    s_nop 6
    v_pk_fma_f32 v[22:23], v[72:73], v[58:59], v[22:23]
    v_pk_fma_f32 v[24:25], v[74:75], v[60:61], v[24:25]
    v_pk_fma_f32 v[26:27], v[76:77], v[62:63], v[26:27]
    v_pk_fma_f32 v[28:29], v[78:79], v[64:65], v[28:29]
    v_cvt_pk_bf16_f32 v22, v22, v23
    v_cvt_pk_bf16_f32 v23, v24, v25
    ds_write_b64 v70, v[22:23] offset:0
    v_cvt_pk_bf16_f32 v26, v26, v27
    v_cvt_pk_bf16_f32 v27, v28, v29
    ds_write_b64 v70, v[26:27] offset:512
    ds_read_b128 v[72:75], v71 offset:0
    s_waitcnt lgkmcnt(0)
    s_setprio 3
    s_waitcnt vmcnt(0)
    s_bitcmp1_b32 s43, 5
    s_cbranch_scc0 L_fa_114
    s_waitcnt vmcnt(1)
    ds_read_b64_tr_b16 v[22:23], v3 offset:0
    ds_read_b64_tr_b16 v[24:25], v4 offset:0
    ds_read_b64_tr_b16 v[26:27], v3 offset:1024
    ds_read_b64_tr_b16 v[28:29], v4 offset:1024
    s_mov_b32 m0, s38
    s_waitcnt lgkmcnt(0)
    v_mfma_f32_16x16x32_bf16 v[80:83], v[22:25], v[14:17], v[80:83]
    v_mfma_f32_16x16x32_bf16 v[84:87], v[26:29], v[18:21], v[84:87]
L_fa_114:
    s_bitcmp1_b32 s43, 4
    s_cbranch_scc0 L_fb_115
    s_mov_b32 m0, s38
    v_lshl_or_b32 v9, v34, 5, 16
    s_nop 1
    v_and_b32_dpp v7, v9, v6 quad_perm:[0,0,2,2] row_mask:0xf bank_mask:0xf
    v_and_b32_dpp v8, v9, v6 quad_perm:[1,1,3,3] row_mask:0xf bank_mask:0xf
    buffer_load_dwordx4 v7, s[16:19], 0 offen lds
    s_add_u32 m0, s38, 1024
    s_nop 0
    buffer_load_dwordx4 v8, s[16:19], 0 offen lds
    v_and_b32_sdwa v9, s40, v34 dst_sel:DWORD dst_unused:UNUSED_PAD src0_sel:DWORD src1_sel:BYTE_2
    v_add_u32 v9, v9, v1
    ds_write_b16 v9, v35
    ds_read_b128 v[14:17], v2
    ds_read_b128 v[18:21], v2 offset:1024
    ds_write_b16 v9, v5
L_fb_115:
    s_add_u32 s37, s51, 0
    s_mov_b32 m0, s37
    s_mov_b32 s37, 57344
    buffer_load_dwordx4 v12, s[4:7], s37 offen  lds
    ds_read_u16 v52, v13 offset:320
    ds_read_u16 v55, v13 offset:352
    ds_read_b64 v[22:23], v70 offset:1024
    ds_read_b64 v[26:27], v70 offset:1536
    s_waitcnt lgkmcnt(2)
    v_lshlrev_b32 v52, 16, v52
    v_lshlrev_b32 v55, 16, v55
    v_sub_f32 v58, v52, v56
    v_sub_f32 v59, v52, v57
    v_sub_f32 v62, v55, v56
    v_sub_f32 v63, v55, v57
    v_cvt_pk_bf16_f32 v58, 0, v58
    v_cvt_pk_bf16_f32 v59, 0, v59
    v_cvt_pk_bf16_f32 v62, 0, v62
    v_cvt_pk_bf16_f32 v63, 0, v63
    v_pk_mul_f32 v[58:59], v[58:59], v[58:59]
    v_pk_mul_f32 v[62:63], v[62:63], v[62:63]
    v_cvt_pk_bf16_f32 v58, 0, v58
    v_cvt_pk_bf16_f32 v59, 0, v59
    v_cvt_pk_bf16_f32 v62, 0, v62
    v_cvt_pk_bf16_f32 v63, 0, v63
    v_pk_mul_f32 v[58:59], v[58:59], s[46:47]
    v_pk_mul_f32 v[62:63], v[62:63], s[46:47]
    v_cvt_pk_bf16_f32 v58, 0, v58
    v_cvt_pk_bf16_f32 v59, 0, v59
    v_cvt_pk_bf16_f32 v62, 0, v62
    v_cvt_pk_bf16_f32 v63, 0, v63
    v_pk_mul_f32 v[58:59], v[58:59], s[48:49]
    v_pk_mul_f32 v[62:63], v[62:63], s[48:49]
    v_exp_f32 v58, v58
    v_exp_f32 v59, v59
    v_exp_f32 v62, v62
    v_exp_f32 v63, v63
    v_cvt_pk_bf16_f32 v66, v80, v81
    v_cvt_pk_bf16_f32 v67, v82, v83
    v_cvt_pk_bf16_f32 v68, v84, v85
    v_cvt_pk_bf16_f32 v69, v86, v87
    v_cvt_pk_bf16_f32 v52, v58, v59
    v_cvt_pk_bf16_f32 v55, v62, v63
    v_mfma_f32_16x16x16_bf16 v[80:83], v[44:45], v[66:67], 0
    v_mfma_f32_16x16x16_bf16 v[84:87], v[44:45], v[68:69], 0
    v_mfma_f32_16x16x16_bf16 v[58:61], v[48:49], v[52:53], 0
    v_mfma_f32_16x16x16_bf16 v[62:65], v[50:51], v[54:55], 0
    s_waitcnt lgkmcnt(0)
    v_and_b32 v25, s50, v23
    v_lshlrev_b32 v24, 16, v23
    v_and_b32 v23, s50, v22
    v_lshlrev_b32 v22, 16, v22
    v_and_b32 v29, s50, v27
    v_lshlrev_b32 v28, 16, v27
    v_and_b32 v27, s50, v26
    v_lshlrev_b32 v26, 16, v26
    v_pk_mul_f32 v[58:59], v[58:59], v[80:81]
    v_pk_mul_f32 v[60:61], v[60:61], v[82:83]
    v_pk_mul_f32 v[62:63], v[62:63], v[84:85]
    v_pk_mul_f32 v[64:65], v[64:65], v[86:87]
    v_cvt_pk_bf16_f32 v66, v58, v59
    v_cvt_pk_bf16_f32 v67, v60, v61
    v_cvt_pk_bf16_f32 v68, v62, v63
    v_cvt_pk_bf16_f32 v69, v64, v65
    v_mfma_f32_16x16x16_bf16 v[58:61], v[50:51], v[52:53], 0
    v_mfma_f32_16x16x16_bf16 v[62:65], v[48:49], v[54:55], 0
    v_mfma_f32_16x16x16_bf16 v[80:83], v[46:47], v[66:67], 0
    v_mfma_f32_16x16x16_bf16 v[84:87], v[46:47], v[68:69], 0
    s_nop 6
    v_pk_fma_f32 v[22:23], v[80:81], v[58:59], v[22:23]
    v_pk_fma_f32 v[24:25], v[82:83], v[60:61], v[24:25]
    v_pk_fma_f32 v[26:27], v[84:85], v[62:63], v[26:27]
    v_pk_fma_f32 v[28:29], v[86:87], v[64:65], v[28:29]
    v_cvt_pk_bf16_f32 v22, v22, v23
    v_cvt_pk_bf16_f32 v23, v24, v25
    ds_write_b64 v70, v[22:23] offset:1024
    v_cvt_pk_bf16_f32 v26, v26, v27
    v_cvt_pk_bf16_f32 v27, v28, v29
    ds_write_b64 v70, v[26:27] offset:1536
    ds_read_b128 v[80:83], v71 offset:1024
    s_mov_b32 s37, 86016
    buffer_store_dwordx4 v[72:75], v12, s[20:23], s37 offen sc1
    s_waitcnt lgkmcnt(0)
    s_setprio 3
    s_waitcnt vmcnt(1)
    s_bitcmp1_b32 s43, 4
    s_cbranch_scc0 L_fa_116
    s_waitcnt vmcnt(2)
    ds_read_b64_tr_b16 v[22:23], v3 offset:0
    ds_read_b64_tr_b16 v[24:25], v4 offset:0
    ds_read_b64_tr_b16 v[26:27], v3 offset:1024
    ds_read_b64_tr_b16 v[28:29], v4 offset:1024
    s_mov_b32 m0, s38
    s_waitcnt lgkmcnt(0)
    v_mfma_f32_16x16x32_bf16 v[88:91], v[22:25], v[14:17], v[88:91]
    v_mfma_f32_16x16x32_bf16 v[92:95], v[26:29], v[18:21], v[92:95]
L_fa_116:
    s_bitcmp1_b32 s43, 3
    s_cbranch_scc0 L_fb_117
    s_mov_b32 m0, s38
    v_lshl_or_b32 v9, v36, 5, 16
    s_nop 1
    v_and_b32_dpp v7, v9, v6 quad_perm:[0,0,2,2] row_mask:0xf bank_mask:0xf
    v_and_b32_dpp v8, v9, v6 quad_perm:[1,1,3,3] row_mask:0xf bank_mask:0xf
    buffer_load_dwordx4 v7, s[16:19], 0 offen lds
    s_add_u32 m0, s38, 1024
    s_nop 0
    buffer_load_dwordx4 v8, s[16:19], 0 offen lds
    v_and_b32_sdwa v9, s40, v36 dst_sel:DWORD dst_unused:UNUSED_PAD src0_sel:DWORD src1_sel:BYTE_2
    v_add_u32 v9, v9, v1
    ds_write_b16 v9, v37
    ds_read_b128 v[14:17], v2
    ds_read_b128 v[18:21], v2 offset:1024
    ds_write_b16 v9, v5
L_fb_117:
    s_add_u32 s37, s51, 1024
    s_mov_b32 m0, s37
    s_mov_b32 s37, 43008
    buffer_load_dwordx4 v12, s[4:7], s37 offen  lds
    ds_read_u16 v52, v13 offset:256
    ds_read_u16 v55, v13 offset:288
    ds_read_b64 v[22:23], v70 offset:0
    ds_read_b64 v[26:27], v70 offset:512
    s_waitcnt lgkmcnt(2)
    v_lshlrev_b32 v52, 16, v52
    v_lshlrev_b32 v55, 16, v55
    v_sub_f32 v58, v52, v56
    v_sub_f32 v59, v52, v57
    v_sub_f32 v62, v55, v56
    v_sub_f32 v63, v55, v57
    v_cvt_pk_bf16_f32 v58, 0, v58
    v_cvt_pk_bf16_f32 v59, 0, v59
    v_cvt_pk_bf16_f32 v62, 0, v62
    v_cvt_pk_bf16_f32 v63, 0, v63
    v_pk_mul_f32 v[58:59], v[58:59], v[58:59]
    v_pk_mul_f32 v[62:63], v[62:63], v[62:63]
    v_cvt_pk_bf16_f32 v58, 0, v58
    v_cvt_pk_bf16_f32 v59, 0, v59
    v_cvt_pk_bf16_f32 v62, 0, v62
    v_cvt_pk_bf16_f32 v63, 0, v63
    v_pk_mul_f32 v[58:59], v[58:59], s[46:47]
    v_pk_mul_f32 v[62:63], v[62:63], s[46:47]
    v_cvt_pk_bf16_f32 v58, 0, v58
    v_cvt_pk_bf16_f32 v59, 0, v59
    v_cvt_pk_bf16_f32 v62, 0, v62
    v_cvt_pk_bf16_f32 v63, 0, v63
    v_pk_mul_f32 v[58:59], v[58:59], s[48:49]
    v_pk_mul_f32 v[62:63], v[62:63], s[48:49]
    v_exp_f32 v58, v58
    v_exp_f32 v59, v59
    v_exp_f32 v62, v62
    v_exp_f32 v63, v63
    v_cvt_pk_bf16_f32 v66, v88, v89
    v_cvt_pk_bf16_f32 v67, v90, v91
    v_cvt_pk_bf16_f32 v68, v92, v93
    v_cvt_pk_bf16_f32 v69, v94, v95
    v_cvt_pk_bf16_f32 v52, v58, v59
    v_cvt_pk_bf16_f32 v55, v62, v63
    v_mfma_f32_16x16x16_bf16 v[88:91], v[44:45], v[66:67], 0
    v_mfma_f32_16x16x16_bf16 v[92:95], v[44:45], v[68:69], 0
    v_mfma_f32_16x16x16_bf16 v[58:61], v[48:49], v[52:53], 0
    v_mfma_f32_16x16x16_bf16 v[62:65], v[50:51], v[54:55], 0
    s_waitcnt lgkmcnt(0)
    v_and_b32 v25, s50, v23
    v_lshlrev_b32 v24, 16, v23
    v_and_b32 v23, s50, v22
    v_lshlrev_b32 v22, 16, v22
    v_and_b32 v29, s50, v27
    v_lshlrev_b32 v28, 16, v27
    v_and_b32 v27, s50, v26
    v_lshlrev_b32 v26, 16, v26
    v_pk_mul_f32 v[58:59], v[58:59], v[88:89]
    v_pk_mul_f32 v[60:61], v[60:61], v[90:91]
    v_pk_mul_f32 v[62:63], v[62:63], v[92:93]
    v_pk_mul_f32 v[64:65], v[64:65], v[94:95]
    v_cvt_pk_bf16_f32 v66, v58, v59
    v_cvt_pk_bf16_f32 v67, v60, v61
    v_cvt_pk_bf16_f32 v68, v62, v63
    v_cvt_pk_bf16_f32 v69, v64, v65
    v_mfma_f32_16x16x16_bf16 v[58:61], v[50:51], v[52:53], 0
    v_mfma_f32_16x16x16_bf16 v[62:65], v[48:49], v[54:55], 0
    v_mfma_f32_16x16x16_bf16 v[88:91], v[46:47], v[66:67], 0
    v_mfma_f32_16x16x16_bf16 v[92:95], v[46:47], v[68:69], 0
    s_nop 6
    v_pk_fma_f32 v[22:23], v[88:89], v[58:59], v[22:23]
    v_pk_fma_f32 v[24:25], v[90:91], v[60:61], v[24:25]
    v_pk_fma_f32 v[26:27], v[92:93], v[62:63], v[26:27]
    v_pk_fma_f32 v[28:29], v[94:95], v[64:65], v[28:29]
    v_cvt_pk_bf16_f32 v22, v22, v23
    v_cvt_pk_bf16_f32 v23, v24, v25
    ds_write_b64 v70, v[22:23] offset:0
    v_cvt_pk_bf16_f32 v26, v26, v27
    v_cvt_pk_bf16_f32 v27, v28, v29
    ds_write_b64 v70, v[26:27] offset:512
    ds_read_b128 v[88:91], v71 offset:0
    s_mov_b32 s37, 71680
    buffer_store_dwordx4 v[80:83], v12, s[20:23], s37 offen sc1
    s_waitcnt lgkmcnt(0)
    s_setprio 2
    s_waitcnt vmcnt(1)
    s_bitcmp1_b32 s43, 3
    s_cbranch_scc0 L_fa_118
    s_waitcnt vmcnt(2)
    ds_read_b64_tr_b16 v[22:23], v3 offset:0
    ds_read_b64_tr_b16 v[24:25], v4 offset:0
    ds_read_b64_tr_b16 v[26:27], v3 offset:1024
    ds_read_b64_tr_b16 v[28:29], v4 offset:1024
    s_mov_b32 m0, s38
    s_waitcnt lgkmcnt(0)
    v_mfma_f32_16x16x32_bf16 v[96:99], v[22:25], v[14:17], v[96:99]
    v_mfma_f32_16x16x32_bf16 v[100:103], v[26:29], v[18:21], v[100:103]
L_fa_118:
    s_bitcmp1_b32 s43, 2
    s_cbranch_scc0 L_fb_119
    s_mov_b32 m0, s38
    v_lshl_or_b32 v9, v38, 5, 16
    s_nop 1
    v_and_b32_dpp v7, v9, v6 quad_perm:[0,0,2,2] row_mask:0xf bank_mask:0xf
    v_and_b32_dpp v8, v9, v6 quad_perm:[1,1,3,3] row_mask:0xf bank_mask:0xf
    buffer_load_dwordx4 v7, s[16:19], 0 offen lds
    s_add_u32 m0, s38, 1024
    s_nop 0
    buffer_load_dwordx4 v8, s[16:19], 0 offen lds
    v_and_b32_sdwa v9, s40, v38 dst_sel:DWORD dst_unused:UNUSED_PAD src0_sel:DWORD src1_sel:BYTE_2
    v_add_u32 v9, v9, v1
    ds_write_b16 v9, v39
    ds_read_b128 v[14:17], v2
    ds_read_b128 v[18:21], v2 offset:1024
    ds_write_b16 v9, v5
L_fb_119:
    s_add_u32 s37, s51, 0
    s_mov_b32 m0, s37
    s_mov_b32 s37, 28672
    buffer_load_dwordx4 v12, s[4:7], s37 offen  lds
    ds_read_u16 v52, v13 offset:192
    ds_read_u16 v55, v13 offset:224
    ds_read_b64 v[22:23], v70 offset:1024
    ds_read_b64 v[26:27], v70 offset:1536
    s_waitcnt lgkmcnt(2)
    v_lshlrev_b32 v52, 16, v52
    v_lshlrev_b32 v55, 16, v55
    v_sub_f32 v58, v52, v56
    v_sub_f32 v59, v52, v57
    v_sub_f32 v62, v55, v56
    v_sub_f32 v63, v55, v57
    v_cvt_pk_bf16_f32 v58, 0, v58
    v_cvt_pk_bf16_f32 v59, 0, v59
    v_cvt_pk_bf16_f32 v62, 0, v62
    v_cvt_pk_bf16_f32 v63, 0, v63
    v_pk_mul_f32 v[58:59], v[58:59], v[58:59]
    v_pk_mul_f32 v[62:63], v[62:63], v[62:63]
    v_cvt_pk_bf16_f32 v58, 0, v58
    v_cvt_pk_bf16_f32 v59, 0, v59
    v_cvt_pk_bf16_f32 v62, 0, v62
    v_cvt_pk_bf16_f32 v63, 0, v63
    v_pk_mul_f32 v[58:59], v[58:59], s[46:47]
    v_pk_mul_f32 v[62:63], v[62:63], s[46:47]
    v_cvt_pk_bf16_f32 v58, 0, v58
    v_cvt_pk_bf16_f32 v59, 0, v59
    v_cvt_pk_bf16_f32 v62, 0, v62
    v_cvt_pk_bf16_f32 v63, 0, v63
    v_pk_mul_f32 v[58:59], v[58:59], s[48:49]
    v_pk_mul_f32 v[62:63], v[62:63], s[48:49]
    v_exp_f32 v58, v58
    v_exp_f32 v59, v59
    v_exp_f32 v62, v62
    v_exp_f32 v63, v63
    v_cvt_pk_bf16_f32 v66, v96, v97
    v_cvt_pk_bf16_f32 v67, v98, v99
    v_cvt_pk_bf16_f32 v68, v100, v101
    v_cvt_pk_bf16_f32 v69, v102, v103
    v_cvt_pk_bf16_f32 v52, v58, v59
    v_cvt_pk_bf16_f32 v55, v62, v63
    v_mfma_f32_16x16x16_bf16 v[96:99], v[44:45], v[66:67], 0
    v_mfma_f32_16x16x16_bf16 v[100:103], v[44:45], v[68:69], 0
    v_mfma_f32_16x16x16_bf16 v[58:61], v[48:49], v[52:53], 0
    v_mfma_f32_16x16x16_bf16 v[62:65], v[50:51], v[54:55], 0
    s_waitcnt lgkmcnt(0)
    v_and_b32 v25, s50, v23
    v_lshlrev_b32 v24, 16, v23
    v_and_b32 v23, s50, v22
    v_lshlrev_b32 v22, 16, v22
    v_and_b32 v29, s50, v27
    v_lshlrev_b32 v28, 16, v27
    v_and_b32 v27, s50, v26
    v_lshlrev_b32 v26, 16, v26
    v_pk_mul_f32 v[58:59], v[58:59], v[96:97]
    v_pk_mul_f32 v[60:61], v[60:61], v[98:99]
    v_pk_mul_f32 v[62:63], v[62:63], v[100:101]
    v_pk_mul_f32 v[64:65], v[64:65], v[102:103]
    v_cvt_pk_bf16_f32 v66, v58, v59
    v_cvt_pk_bf16_f32 v67, v60, v61
    v_cvt_pk_bf16_f32 v68, v62, v63
    v_cvt_pk_bf16_f32 v69, v64, v65
    v_mfma_f32_16x16x16_bf16 v[58:61], v[50:51], v[52:53], 0
    v_mfma_f32_16x16x16_bf16 v[62:65], v[48:49], v[54:55], 0
    v_mfma_f32_16x16x16_bf16 v[96:99], v[46:47], v[66:67], 0
    v_mfma_f32_16x16x16_bf16 v[100:103], v[46:47], v[68:69], 0
    s_nop 6
    v_pk_fma_f32 v[22:23], v[96:97], v[58:59], v[22:23]
    v_pk_fma_f32 v[24:25], v[98:99], v[60:61], v[24:25]
    v_pk_fma_f32 v[26:27], v[100:101], v[62:63], v[26:27]
    v_pk_fma_f32 v[28:29], v[102:103], v[64:65], v[28:29]
    v_cvt_pk_bf16_f32 v22, v22, v23
    v_cvt_pk_bf16_f32 v23, v24, v25
    ds_write_b64 v70, v[22:23] offset:1024
    v_cvt_pk_bf16_f32 v26, v26, v27
    v_cvt_pk_bf16_f32 v27, v28, v29
    ds_write_b64 v70, v[26:27] offset:1536
    ds_read_b128 v[96:99], v71 offset:1024
    s_mov_b32 s37, 57344
    buffer_store_dwordx4 v[88:91], v12, s[20:23], s37 offen sc1
    s_waitcnt lgkmcnt(0)
    s_setprio 2
    s_waitcnt vmcnt(1)
    s_bitcmp1_b32 s43, 2
    s_cbranch_scc0 L_fa_120
    s_waitcnt vmcnt(2)
    ds_read_b64_tr_b16 v[22:23], v3 offset:0
    ds_read_b64_tr_b16 v[24:25], v4 offset:0
    ds_read_b64_tr_b16 v[26:27], v3 offset:1024
    ds_read_b64_tr_b16 v[28:29], v4 offset:1024
    s_mov_b32 m0, s38
    s_waitcnt lgkmcnt(0)
    v_mfma_f32_16x16x32_bf16 v[104:107], v[22:25], v[14:17], v[104:107]
    v_mfma_f32_16x16x32_bf16 v[108:111], v[26:29], v[18:21], v[108:111]
L_fa_120:
    s_bitcmp1_b32 s43, 1
    s_cbranch_scc0 L_fb_121
    s_mov_b32 m0, s38
    v_lshl_or_b32 v9, v40, 5, 16
    s_nop 1
    v_and_b32_dpp v7, v9, v6 quad_perm:[0,0,2,2] row_mask:0xf bank_mask:0xf
    v_and_b32_dpp v8, v9, v6 quad_perm:[1,1,3,3] row_mask:0xf bank_mask:0xf
    buffer_load_dwordx4 v7, s[16:19], 0 offen lds
    s_add_u32 m0, s38, 1024
    s_nop 0
    buffer_load_dwordx4 v8, s[16:19], 0 offen lds
    v_and_b32_sdwa v9, s40, v40 dst_sel:DWORD dst_unused:UNUSED_PAD src0_sel:DWORD src1_sel:BYTE_2
    v_add_u32 v9, v9, v1
    ds_write_b16 v9, v41
    ds_read_b128 v[14:17], v2
    ds_read_b128 v[18:21], v2 offset:1024
    ds_write_b16 v9, v5
L_fb_121:
    s_add_u32 s37, s51, 1024
    s_mov_b32 m0, s37
    s_mov_b32 s37, 14336
    buffer_load_dwordx4 v12, s[4:7], s37 offen  lds
    ds_read_u16 v52, v13 offset:128
    ds_read_u16 v55, v13 offset:160
    ds_read_b64 v[22:23], v70 offset:0
    ds_read_b64 v[26:27], v70 offset:512
    s_waitcnt lgkmcnt(2)
    v_lshlrev_b32 v52, 16, v52
    v_lshlrev_b32 v55, 16, v55
    v_sub_f32 v58, v52, v56
    v_sub_f32 v59, v52, v57
    v_sub_f32 v62, v55, v56
    v_sub_f32 v63, v55, v57
    v_cvt_pk_bf16_f32 v58, 0, v58
    v_cvt_pk_bf16_f32 v59, 0, v59
    v_cvt_pk_bf16_f32 v62, 0, v62
    v_cvt_pk_bf16_f32 v63, 0, v63
    v_pk_mul_f32 v[58:59], v[58:59], v[58:59]
    v_pk_mul_f32 v[62:63], v[62:63], v[62:63]
    v_cvt_pk_bf16_f32 v58, 0, v58
    v_cvt_pk_bf16_f32 v59, 0, v59
    v_cvt_pk_bf16_f32 v62, 0, v62
    v_cvt_pk_bf16_f32 v63, 0, v63
    v_pk_mul_f32 v[58:59], v[58:59], s[46:47]
    v_pk_mul_f32 v[62:63], v[62:63], s[46:47]
    v_cvt_pk_bf16_f32 v58, 0, v58
    v_cvt_pk_bf16_f32 v59, 0, v59
    v_cvt_pk_bf16_f32 v62, 0, v62
    v_cvt_pk_bf16_f32 v63, 0, v63
    v_pk_mul_f32 v[58:59], v[58:59], s[48:49]
    v_pk_mul_f32 v[62:63], v[62:63], s[48:49]
    v_exp_f32 v58, v58
    v_exp_f32 v59, v59
    v_exp_f32 v62, v62
    v_exp_f32 v63, v63
    v_cvt_pk_bf16_f32 v66, v104, v105
    v_cvt_pk_bf16_f32 v67, v106, v107
    v_cvt_pk_bf16_f32 v68, v108, v109
    v_cvt_pk_bf16_f32 v69, v110, v111
    v_cvt_pk_bf16_f32 v52, v58, v59
    v_cvt_pk_bf16_f32 v55, v62, v63
    v_mfma_f32_16x16x16_bf16 v[104:107], v[44:45], v[66:67], 0
    v_mfma_f32_16x16x16_bf16 v[108:111], v[44:45], v[68:69], 0
    v_mfma_f32_16x16x16_bf16 v[58:61], v[48:49], v[52:53], 0
    v_mfma_f32_16x16x16_bf16 v[62:65], v[50:51], v[54:55], 0
    s_waitcnt lgkmcnt(0)
    v_and_b32 v25, s50, v23
    v_lshlrev_b32 v24, 16, v23
    v_and_b32 v23, s50, v22
    v_lshlrev_b32 v22, 16, v22
    v_and_b32 v29, s50, v27
    v_lshlrev_b32 v28, 16, v27
    v_and_b32 v27, s50, v26
    v_lshlrev_b32 v26, 16, v26
    v_pk_mul_f32 v[58:59], v[58:59], v[104:105]
    v_pk_mul_f32 v[60:61], v[60:61], v[106:107]
    v_pk_mul_f32 v[62:63], v[62:63], v[108:109]
    v_pk_mul_f32 v[64:65], v[64:65], v[110:111]
    v_cvt_pk_bf16_f32 v66, v58, v59
    v_cvt_pk_bf16_f32 v67, v60, v61
    v_cvt_pk_bf16_f32 v68, v62, v63
    v_cvt_pk_bf16_f32 v69, v64, v65
    v_mfma_f32_16x16x16_bf16 v[58:61], v[50:51], v[52:53], 0
    v_mfma_f32_16x16x16_bf16 v[62:65], v[48:49], v[54:55], 0
    v_mfma_f32_16x16x16_bf16 v[104:107], v[46:47], v[66:67], 0
    v_mfma_f32_16x16x16_bf16 v[108:111], v[46:47], v[68:69], 0
    s_nop 6
    v_pk_fma_f32 v[22:23], v[104:105], v[58:59], v[22:23]
    v_pk_fma_f32 v[24:25], v[106:107], v[60:61], v[24:25]
    v_pk_fma_f32 v[26:27], v[108:109], v[62:63], v[26:27]
    v_pk_fma_f32 v[28:29], v[110:111], v[64:65], v[28:29]
    v_cvt_pk_bf16_f32 v22, v22, v23
    v_cvt_pk_bf16_f32 v23, v24, v25
    ds_write_b64 v70, v[22:23] offset:0
    v_cvt_pk_bf16_f32 v26, v26, v27
    v_cvt_pk_bf16_f32 v27, v28, v29
    ds_write_b64 v70, v[26:27] offset:512
    ds_read_b128 v[104:107], v71 offset:0
    s_mov_b32 s37, 43008
    buffer_store_dwordx4 v[96:99], v12, s[20:23], s37 offen sc1
    s_waitcnt lgkmcnt(0)
    s_setprio 1
    s_waitcnt vmcnt(1)
    s_bitcmp1_b32 s43, 1
    s_cbranch_scc0 L_fa_122
    s_waitcnt vmcnt(2)
    ds_read_b64_tr_b16 v[22:23], v3 offset:0
    ds_read_b64_tr_b16 v[24:25], v4 offset:0
    ds_read_b64_tr_b16 v[26:27], v3 offset:1024
    ds_read_b64_tr_b16 v[28:29], v4 offset:1024
    s_mov_b32 m0, s38
    s_waitcnt lgkmcnt(0)
    v_mfma_f32_16x16x32_bf16 v[112:115], v[22:25], v[14:17], v[112:115]
    v_mfma_f32_16x16x32_bf16 v[116:119], v[26:29], v[18:21], v[116:119]
L_fa_122:
    s_bitcmp1_b32 s43, 0
    s_cbranch_scc0 L_fb_123
    s_mov_b32 m0, s38
    v_lshl_or_b32 v9, v42, 5, 16
    s_nop 1
    v_and_b32_dpp v7, v9, v6 quad_perm:[0,0,2,2] row_mask:0xf bank_mask:0xf
    v_and_b32_dpp v8, v9, v6 quad_perm:[1,1,3,3] row_mask:0xf bank_mask:0xf
    buffer_load_dwordx4 v7, s[16:19], 0 offen lds
    s_add_u32 m0, s38, 1024
    s_nop 0
    buffer_load_dwordx4 v8, s[16:19], 0 offen lds
    v_and_b32_sdwa v9, s40, v42 dst_sel:DWORD dst_unused:UNUSED_PAD src0_sel:DWORD src1_sel:BYTE_2
    v_add_u32 v9, v9, v1
    ds_write_b16 v9, v43
    ds_read_b128 v[14:17], v2
    ds_read_b128 v[18:21], v2 offset:1024
    ds_write_b16 v9, v5
L_fb_123:
    s_add_u32 s37, s51, 0
    s_mov_b32 m0, s37
    s_mov_b32 s37, 0
    buffer_load_dwordx4 v12, s[4:7], s37 offen  lds
    ds_read_u16 v52, v13 offset:64
    ds_read_u16 v55, v13 offset:96
    ds_read_b64 v[22:23], v70 offset:1024
    ds_read_b64 v[26:27], v70 offset:1536
    s_waitcnt lgkmcnt(2)
    v_lshlrev_b32 v52, 16, v52
    v_lshlrev_b32 v55, 16, v55
    v_sub_f32 v58, v52, v56
    v_sub_f32 v59, v52, v57
    v_sub_f32 v62, v55, v56
    v_sub_f32 v63, v55, v57
    v_cvt_pk_bf16_f32 v58, 0, v58
    v_cvt_pk_bf16_f32 v59, 0, v59
    v_cvt_pk_bf16_f32 v62, 0, v62
    v_cvt_pk_bf16_f32 v63, 0, v63
    v_pk_mul_f32 v[58:59], v[58:59], v[58:59]
    v_pk_mul_f32 v[62:63], v[62:63], v[62:63]
    v_cvt_pk_bf16_f32 v58, 0, v58
    v_cvt_pk_bf16_f32 v59, 0, v59
    v_cvt_pk_bf16_f32 v62, 0, v62
    v_cvt_pk_bf16_f32 v63, 0, v63
    v_pk_mul_f32 v[58:59], v[58:59], s[46:47]
    v_pk_mul_f32 v[62:63], v[62:63], s[46:47]
    v_cvt_pk_bf16_f32 v58, 0, v58
    v_cvt_pk_bf16_f32 v59, 0, v59
    v_cvt_pk_bf16_f32 v62, 0, v62
    v_cvt_pk_bf16_f32 v63, 0, v63
    v_pk_mul_f32 v[58:59], v[58:59], s[48:49]
    v_pk_mul_f32 v[62:63], v[62:63], s[48:49]
    v_exp_f32 v58, v58
    v_exp_f32 v59, v59
    v_exp_f32 v62, v62
    v_exp_f32 v63, v63
    v_cvt_pk_bf16_f32 v66, v112, v113
    v_cvt_pk_bf16_f32 v67, v114, v115
    v_cvt_pk_bf16_f32 v68, v116, v117
    v_cvt_pk_bf16_f32 v69, v118, v119
    v_cvt_pk_bf16_f32 v52, v58, v59
    v_cvt_pk_bf16_f32 v55, v62, v63
    v_mfma_f32_16x16x16_bf16 v[112:115], v[44:45], v[66:67], 0
    v_mfma_f32_16x16x16_bf16 v[116:119], v[44:45], v[68:69], 0
    v_mfma_f32_16x16x16_bf16 v[58:61], v[48:49], v[52:53], 0
    v_mfma_f32_16x16x16_bf16 v[62:65], v[50:51], v[54:55], 0
    s_waitcnt lgkmcnt(0)
    v_and_b32 v25, s50, v23
    v_lshlrev_b32 v24, 16, v23
    v_and_b32 v23, s50, v22
    v_lshlrev_b32 v22, 16, v22
    v_and_b32 v29, s50, v27
    v_lshlrev_b32 v28, 16, v27
    v_and_b32 v27, s50, v26
    v_lshlrev_b32 v26, 16, v26
    v_pk_mul_f32 v[58:59], v[58:59], v[112:113]
    v_pk_mul_f32 v[60:61], v[60:61], v[114:115]
    v_pk_mul_f32 v[62:63], v[62:63], v[116:117]
    v_pk_mul_f32 v[64:65], v[64:65], v[118:119]
    v_cvt_pk_bf16_f32 v66, v58, v59
    v_cvt_pk_bf16_f32 v67, v60, v61
    v_cvt_pk_bf16_f32 v68, v62, v63
    v_cvt_pk_bf16_f32 v69, v64, v65
    v_mfma_f32_16x16x16_bf16 v[58:61], v[50:51], v[52:53], 0
    v_mfma_f32_16x16x16_bf16 v[62:65], v[48:49], v[54:55], 0
    v_mfma_f32_16x16x16_bf16 v[112:115], v[46:47], v[66:67], 0
    v_mfma_f32_16x16x16_bf16 v[116:119], v[46:47], v[68:69], 0
    s_nop 6
    v_pk_fma_f32 v[22:23], v[112:113], v[58:59], v[22:23]
    v_pk_fma_f32 v[24:25], v[114:115], v[60:61], v[24:25]
    v_pk_fma_f32 v[26:27], v[116:117], v[62:63], v[26:27]
    v_pk_fma_f32 v[28:29], v[118:119], v[64:65], v[28:29]
    v_cvt_pk_bf16_f32 v22, v22, v23
    v_cvt_pk_bf16_f32 v23, v24, v25
    ds_write_b64 v70, v[22:23] offset:1024
    v_cvt_pk_bf16_f32 v26, v26, v27
    v_cvt_pk_bf16_f32 v27, v28, v29
    ds_write_b64 v70, v[26:27] offset:1536
    ds_read_b128 v[112:115], v71 offset:1024
    s_mov_b32 s37, 28672
    buffer_store_dwordx4 v[104:107], v12, s[20:23], s37 offen sc1
    s_mov_b32 s37, 14336
    s_waitcnt lgkmcnt(0)
    buffer_store_dwordx4 v[112:115], v12, s[20:23], s37 offen sc1
    s_setprio 0
    s_waitcnt vmcnt(2)
    s_bitcmp1_b32 s43, 0
    s_cbranch_scc0 L_fa_124
    s_waitcnt vmcnt(3)
    ds_read_b64_tr_b16 v[22:23], v3 offset:0
    ds_read_b64_tr_b16 v[24:25], v4 offset:0
    ds_read_b64_tr_b16 v[26:27], v3 offset:1024
    ds_read_b64_tr_b16 v[28:29], v4 offset:1024
    s_mov_b32 m0, s38
    s_waitcnt lgkmcnt(0)
    v_mfma_f32_16x16x32_bf16 v[120:123], v[22:25], v[14:17], v[120:123]
    v_mfma_f32_16x16x32_bf16 v[124:127], v[26:29], v[18:21], v[124:127]
L_fa_124:
    ds_read_u16 v52, v13 offset:0
    ds_read_u16 v55, v13 offset:32
    ds_read_b64 v[22:23], v70 offset:0
    ds_read_b64 v[26:27], v70 offset:512
    s_waitcnt lgkmcnt(2)
    v_lshlrev_b32 v52, 16, v52
    v_lshlrev_b32 v55, 16, v55
    v_sub_f32 v58, v52, v56
    v_sub_f32 v59, v52, v57
    v_sub_f32 v62, v55, v56
    v_sub_f32 v63, v55, v57
    v_cvt_pk_bf16_f32 v58, 0, v58
    v_cvt_pk_bf16_f32 v59, 0, v59
    v_cvt_pk_bf16_f32 v62, 0, v62
    v_cvt_pk_bf16_f32 v63, 0, v63
    v_pk_mul_f32 v[58:59], v[58:59], v[58:59]
    v_pk_mul_f32 v[62:63], v[62:63], v[62:63]
    v_cvt_pk_bf16_f32 v58, 0, v58
    v_cvt_pk_bf16_f32 v59, 0, v59
    v_cvt_pk_bf16_f32 v62, 0, v62
    v_cvt_pk_bf16_f32 v63, 0, v63
    v_pk_mul_f32 v[58:59], v[58:59], s[46:47]
    v_pk_mul_f32 v[62:63], v[62:63], s[46:47]
    v_cvt_pk_bf16_f32 v58, 0, v58
    v_cvt_pk_bf16_f32 v59, 0, v59
    v_cvt_pk_bf16_f32 v62, 0, v62
    v_cvt_pk_bf16_f32 v63, 0, v63
    v_pk_mul_f32 v[58:59], v[58:59], s[48:49]
    v_pk_mul_f32 v[62:63], v[62:63], s[48:49]
    v_exp_f32 v58, v58
    v_exp_f32 v59, v59
    v_exp_f32 v62, v62
    v_exp_f32 v63, v63
    v_cvt_pk_bf16_f32 v66, v120, v121
    v_cvt_pk_bf16_f32 v67, v122, v123
    v_cvt_pk_bf16_f32 v68, v124, v125
    v_cvt_pk_bf16_f32 v69, v126, v127
    v_cvt_pk_bf16_f32 v52, v58, v59
    v_cvt_pk_bf16_f32 v55, v62, v63
    v_mfma_f32_16x16x16_bf16 v[120:123], v[44:45], v[66:67], 0
    v_mfma_f32_16x16x16_bf16 v[124:127], v[44:45], v[68:69], 0
    v_mfma_f32_16x16x16_bf16 v[58:61], v[48:49], v[52:53], 0
    v_mfma_f32_16x16x16_bf16 v[62:65], v[50:51], v[54:55], 0
    s_waitcnt lgkmcnt(0)
    v_and_b32 v25, s50, v23
    v_lshlrev_b32 v24, 16, v23
    v_and_b32 v23, s50, v22
    v_lshlrev_b32 v22, 16, v22
    v_and_b32 v29, s50, v27
    v_lshlrev_b32 v28, 16, v27
    v_and_b32 v27, s50, v26
    v_lshlrev_b32 v26, 16, v26
    v_pk_mul_f32 v[58:59], v[58:59], v[120:121]
    v_pk_mul_f32 v[60:61], v[60:61], v[122:123]
    v_pk_mul_f32 v[62:63], v[62:63], v[124:125]
    v_pk_mul_f32 v[64:65], v[64:65], v[126:127]
    v_cvt_pk_bf16_f32 v66, v58, v59
    v_cvt_pk_bf16_f32 v67, v60, v61
    v_cvt_pk_bf16_f32 v68, v62, v63
    v_cvt_pk_bf16_f32 v69, v64, v65
    v_mfma_f32_16x16x16_bf16 v[58:61], v[50:51], v[52:53], 0
    v_mfma_f32_16x16x16_bf16 v[62:65], v[48:49], v[54:55], 0
    v_mfma_f32_16x16x16_bf16 v[120:123], v[46:47], v[66:67], 0
    v_mfma_f32_16x16x16_bf16 v[124:127], v[46:47], v[68:69], 0
    s_nop 6
    v_pk_fma_f32 v[22:23], v[120:121], v[58:59], v[22:23]
    v_pk_fma_f32 v[24:25], v[122:123], v[60:61], v[24:25]
    v_pk_fma_f32 v[26:27], v[124:125], v[62:63], v[26:27]
    v_pk_fma_f32 v[28:29], v[126:127], v[64:65], v[28:29]
    v_cvt_pk_bf16_f32 v22, v22, v23
    v_cvt_pk_bf16_f32 v23, v24, v25
    ds_write_b64 v70, v[22:23] offset:0
    v_cvt_pk_bf16_f32 v26, v26, v27
    v_cvt_pk_bf16_f32 v27, v28, v29
    ds_write_b64 v70, v[26:27] offset:512
    ds_read_b128 v[120:123], v71 offset:0
    s_mov_b32 s37, 0
    s_waitcnt lgkmcnt(0)
    buffer_store_dwordx4 v[120:123], v12, s[20:23], s37 offen sc1
L_k2_end:
    s_endpgm
.section .rodata,"a"
.p2align 6
.amdhsa_kernel gs_part_kernel
  .amdhsa_next_free_vgpr 128
  .amdhsa_next_free_sgpr 102
  .amdhsa_accum_offset 128
  .amdhsa_group_segment_fixed_size 0
  .amdhsa_kernarg_size 112
  .amdhsa_user_sgpr_count 2
  .amdhsa_user_sgpr_kernarg_segment_ptr 1
  .amdhsa_system_sgpr_workgroup_id_x 1
  .amdhsa_float_denorm_mode_32 3
.end_amdhsa_kernel
.p2align 6
.amdhsa_kernel gather_scatter__molecular_angular_gemnet__graph_kernel
  .amdhsa_next_free_vgpr 128
  .amdhsa_next_free_sgpr 102
  .amdhsa_accum_offset 128
  .amdhsa_group_segment_fixed_size 0
  .amdhsa_kernarg_size 112
  .amdhsa_user_sgpr_count 2
  .amdhsa_user_sgpr_kernarg_segment_ptr 1
  .amdhsa_system_sgpr_workgroup_id_x 1
  .amdhsa_float_denorm_mode_32 3
.end_amdhsa_kernel
```
